```python
import torch

def _softmax(x, axis=-1):
    return torch.softmax(x, dim=axis)
def _gelu(x):
    return torch.nn.functional.gelu(x, approximate="tanh")
def _silu(x):
    return torch.nn.functional.silu(x)
def _sigmoid(x):
    return torch.sigmoid(x)
def _layernorm(x, axis=-1, eps=1e-5):
    m = x.mean(dim=axis, keepdim=True)
    v = x.var(dim=axis, keepdim=True, unbiased=False)
    return (x - m) / torch.sqrt(v + eps)
def _scatter_add(tgt, idx, src, axis=0):
    return tgt.clone().index_add_(axis, idx, src)
def _segment_sum(src, seg, n):
    out = torch.zeros((n,) + src.shape[1:], dtype=src.dtype)
    return out.index_add_(0, seg, src)
def _pad(x, pw):
    flat = tuple(v for pair in reversed(pw) for v in pair)
    return torch.nn.functional.pad(x, flat)

kernel_name = 'standalone__self_sup_conv_stem_hubert__speech'

def setup_inputs():

    _w = (lambda a: (lambda t: t.to(torch.bfloat16) if t.is_floating_point() else t)(torch.as_tensor(a)))
    B, T, D, K = 2, 16000, 256, 31
    scale = (1.0 / (K * D)) ** 0.5
    return {
        "x": _w((lambda *s: torch.randn(*s, dtype=torch.bfloat16) * 0.05)(B, T, D)),
        "w": _w((lambda *s: torch.randn(*s, dtype=torch.bfloat16) * 0.05)(K, D, D) * scale),
        "b": _w((lambda *s: torch.randn(*s, dtype=torch.bfloat16) * 0.05)(D) * 0.1),
        "gamma": _w(torch.ones((D,), dtype=float)),
        "beta": _w(torch.zeros((D,), dtype=float)),
    }

def reference(x, w, b, gamma, beta):
    B, T, D = x.shape
    K = w.shape[0]
    s = 2
    L = (T - K) // s + 1
    y = torch.einsum('blc,cd->bld', x[:, 0 : s * L : s, :], w[0])
    for i in range(1, K):
        y = y + torch.einsum('blc,cd->bld', x[:, i : i + s * L : s, :], w[i])
    y = y + b[None, None, :]
    mu = y.mean(1, keepdims=True)
    var = ((y - mu) ** 2).mean(1, keepdims=True)
    yn = (y - mu) / torch.sqrt(var + 1e-5)
    yn = yn * gamma[None, None, :] + beta[None, None, :]
    return _gelu(yn)
```

```asm
; @launch grid=(256,1,1) block=(512,1,1) lds=151552
.amdgcn_target "amdgcn-amd-amdhsa--gfx950"
.text
.globl standalone__self_sup_conv_stem_hubert__speech_kernel
.p2align 8
.type standalone__self_sup_conv_stem_hubert__speech_kernel,@function
standalone__self_sup_conv_stem_hubert__speech_kernel:
s_cmp_ge_u32 s2, 256
s_cbranch_scc1 L_end
s_load_dwordx4 s[72:75], s[0:1], 0
v_lshrrev_b32 v1, 6, v0
v_and_b32 v238, 63, v0
v_readfirstlane_b32 s36, v1
s_bfe_u32 s37, s2, 0x10002
s_and_b32 s38, s2, 3
s_lshl_b32 s38, s38, 2
s_bfe_u32 s45, s2, 0x20003
s_or_b32 s38, s38, s45
s_lshr_b32 s39, s2, 5
s_load_dwordx2 s[16:17], s[0:1], 56
s_load_dwordx2 s[20:21], s[0:1], 48
s_cmp_lt_u32 s36, 4
s_cbranch_scc1 L_compute
s_and_b32 s41, s36, 1
s_mul_i32 s45, s37, 8192000
s_mul_i32 s46, s38, 512000
s_add_u32 s45, s45, s46
s_cmp_ge_u32 s36, 6
s_cbranch_scc1 L_trans
s_lshl_b32 s46, s41, 14
s_add_u32 s45, s45, s46
v_lshrrev_b32 v1, 3, v238
v_and_b32 v2, 7, v238
v_lshlrev_b32 v2, 4, v2
v_lshl_add_u32 v4, v1, 11, v2
v_add_u32 v8, s45, v4
v_xor_b32 v9, 32, v8
v_lshrrev_b32 v1, 2, v238
v_and_b32 v3, 48, v2
v_and_b32 v5, 32, v238
v_xor_b32 v5, v5, v3
v_lshl_add_u32 v5, v1, 9, v5
s_lshl_b32 s62, s39, 6
v_add_u32 v10, s62, v5
v_add_u32 v11, 8192, v10
s_lshl_b32 s50, s41, 11
s_lshl_b32 s51, s41, 10
s_add_u32 s51, s51, 65536
s_mov_b32 s56, 0
s_lshl_b32 s54, s41, 14
s_mov_b32 s61, 32768
s_mov_b32 s53, 524288
s_waitcnt lgkmcnt(0)
s_mov_b32 s76, s74
s_and_b32 s77, s75, 0xffff
s_mov_b32 s78, 4063232
s_mov_b32 s79, 0x00020000
s_and_b32 s73, s73, 0xffff
s_mov_b32 s74, 16384000
s_mov_b32 s75, 0x00020000
s_add_u32 m0, s51, 0
s_mov_b32 s60, s56
buffer_load_dwordx4 v8, s[72:75], s60 offen lds
s_add_u32 m0, s51, 2112
s_add_u32 s60, s60, s61
buffer_load_dwordx4 v8, s[72:75], s60 offen lds
s_add_u32 m0, s51, 4224
s_add_u32 s60, s60, s61
buffer_load_dwordx4 v8, s[72:75], s60 offen lds
s_add_u32 m0, s51, 6336
s_add_u32 s60, s60, s61
buffer_load_dwordx4 v8, s[72:75], s60 offen lds
s_add_u32 m0, s51, 8448
s_add_u32 s60, s60, s61
buffer_load_dwordx4 v9, s[72:75], s60 offen lds
s_add_u32 m0, s51, 10560
s_add_u32 s60, s60, s61
buffer_load_dwordx4 v9, s[72:75], s60 offen lds
s_add_u32 m0, s51, 12672
s_add_u32 s60, s60, s61
buffer_load_dwordx4 v9, s[72:75], s60 offen lds
s_add_u32 m0, s51, 14784
s_add_u32 s60, s60, s61
buffer_load_dwordx4 v9, s[72:75], s60 offen lds
s_add_u32 m0, s51, 16896
s_add_u32 s60, s60, s61
buffer_load_dwordx4 v8, s[72:75], s60 offen lds
s_add_u32 m0, s51, 19008
s_add_u32 s60, s60, s61
buffer_load_dwordx4 v8, s[72:75], s60 offen lds
s_add_u32 m0, s51, 21120
s_add_u32 s60, s60, s61
buffer_load_dwordx4 v8, s[72:75], s60 offen lds
s_add_u32 m0, s51, 23232
s_add_u32 s60, s60, s61
buffer_load_dwordx4 v8, s[72:75], s60 offen lds
s_add_u32 m0, s51, 25344
s_add_u32 s60, s60, s61
buffer_load_dwordx4 v9, s[72:75], s60 offen lds
s_add_u32 m0, s51, 27456
s_add_u32 s60, s60, s61
buffer_load_dwordx4 v9, s[72:75], s60 offen lds
s_add_u32 m0, s51, 29568
s_add_u32 s60, s60, s61
buffer_load_dwordx4 v9, s[72:75], s60 offen lds
s_add_u32 m0, s51, 31680
s_add_u32 s60, s60, s61
buffer_load_dwordx4 v9, s[72:75], s60 offen lds
s_cmp_lg_u32 s41, 0
s_cbranch_scc1 L_sk1
s_add_u32 m0, s51, 33792
s_add_u32 s60, s60, s61
buffer_load_dwordx4 v8, s[72:75], s60 offen lds
L_sk1:
s_add_u32 m0, s50, 0
s_mov_b32 s52, s54
buffer_load_dwordx4 v10, s[76:79], s52 offen lds
s_add_u32 m0, m0, 1024
s_nop 0
buffer_load_dwordx4 v11, s[76:79], s52 offen lds
s_add_u32 m0, s50, 4096
s_add_u32 s52, s52, s53
buffer_load_dwordx4 v10, s[76:79], s52 offen lds
s_add_u32 m0, m0, 1024
s_nop 0
buffer_load_dwordx4 v11, s[76:79], s52 offen lds
s_add_u32 m0, s50, 8192
s_add_u32 s52, s52, s53
buffer_load_dwordx4 v10, s[76:79], s52 offen lds
s_add_u32 m0, m0, 1024
s_nop 0
buffer_load_dwordx4 v11, s[76:79], s52 offen lds
s_add_u32 m0, s50, 12288
s_add_u32 s52, s52, s53
buffer_load_dwordx4 v10, s[76:79], s52 offen lds
s_add_u32 m0, m0, 1024
s_nop 0
buffer_load_dwordx4 v11, s[76:79], s52 offen lds
s_add_u32 s57, s56, 512
s_add_u32 s55, s54, 131072
s_mov_b32 s58, 32768
s_mov_b32 s59, 128
s_add_u32 m0, s51, 34816
s_mov_b32 s60, s57
buffer_load_dwordx4 v8, s[72:75], s60 offen lds
s_add_u32 m0, s51, 36928
s_add_u32 s60, s60, s61
buffer_load_dwordx4 v8, s[72:75], s60 offen lds
s_add_u32 m0, s51, 39040
s_add_u32 s60, s60, s61
buffer_load_dwordx4 v8, s[72:75], s60 offen lds
s_add_u32 m0, s51, 41152
s_add_u32 s60, s60, s61
buffer_load_dwordx4 v8, s[72:75], s60 offen lds
s_add_u32 m0, s51, 43264
s_add_u32 s60, s60, s61
buffer_load_dwordx4 v9, s[72:75], s60 offen lds
s_add_u32 m0, s51, 45376
s_add_u32 s60, s60, s61
buffer_load_dwordx4 v9, s[72:75], s60 offen lds
s_add_u32 m0, s51, 47488
s_add_u32 s60, s60, s61
buffer_load_dwordx4 v9, s[72:75], s60 offen lds
s_add_u32 m0, s51, 49600
s_add_u32 s60, s60, s61
buffer_load_dwordx4 v9, s[72:75], s60 offen lds
s_add_u32 m0, s51, 51712
s_add_u32 s60, s60, s61
buffer_load_dwordx4 v8, s[72:75], s60 offen lds
s_add_u32 m0, s51, 53824
s_add_u32 s60, s60, s61
buffer_load_dwordx4 v8, s[72:75], s60 offen lds
s_add_u32 m0, s51, 55936
s_add_u32 s60, s60, s61
buffer_load_dwordx4 v8, s[72:75], s60 offen lds
s_add_u32 m0, s51, 58048
s_add_u32 s60, s60, s61
buffer_load_dwordx4 v8, s[72:75], s60 offen lds
s_add_u32 m0, s51, 60160
s_add_u32 s60, s60, s61
buffer_load_dwordx4 v9, s[72:75], s60 offen lds
s_add_u32 m0, s51, 62272
s_add_u32 s60, s60, s61
buffer_load_dwordx4 v9, s[72:75], s60 offen lds
s_add_u32 m0, s51, 64384
s_add_u32 s60, s60, s61
buffer_load_dwordx4 v9, s[72:75], s60 offen lds
s_add_u32 m0, s51, 66496
s_add_u32 s60, s60, s61
buffer_load_dwordx4 v9, s[72:75], s60 offen lds
s_cmp_lg_u32 s41, 0
s_cbranch_scc1 L_sk2
s_add_u32 m0, s51, 68608
s_add_u32 s60, s60, s61
buffer_load_dwordx4 v8, s[72:75], s60 offen lds
L_sk2:
s_add_u32 m0, s50, 16384
s_add_u32 s52, s52, s53
buffer_load_dwordx4 v10, s[76:79], s52 offen lds
s_add_u32 m0, m0, 1024
s_nop 0
buffer_load_dwordx4 v11, s[76:79], s52 offen lds
s_add_u32 m0, s50, 20480
s_add_u32 s52, s52, s53
buffer_load_dwordx4 v10, s[76:79], s52 offen lds
s_add_u32 m0, m0, 1024
s_nop 0
buffer_load_dwordx4 v11, s[76:79], s52 offen lds
s_add_u32 m0, s50, 24576
s_add_u32 s52, s52, s53
buffer_load_dwordx4 v10, s[76:79], s52 offen lds
s_add_u32 m0, m0, 1024
s_nop 0
buffer_load_dwordx4 v11, s[76:79], s52 offen lds
s_add_u32 m0, s50, 28672
s_add_u32 s52, s52, s53
buffer_load_dwordx4 v10, s[76:79], s52 offen lds
s_add_u32 m0, m0, 1024
s_nop 0
buffer_load_dwordx4 v11, s[76:79], s52 offen lds
s_barrier
s_add_u32 m0, s50, 32768
s_mov_b32 s52, s55
buffer_load_dwordx4 v10, s[76:79], s52 offen lds
s_add_u32 m0, m0, 1024
s_nop 0
buffer_load_dwordx4 v11, s[76:79], s52 offen lds
s_add_u32 m0, s50, 36864
s_add_u32 s52, s52, s53
buffer_load_dwordx4 v10, s[76:79], s52 offen lds
s_add_u32 m0, m0, 1024
s_nop 0
buffer_load_dwordx4 v11, s[76:79], s52 offen lds
s_add_u32 m0, s50, 40960
s_add_u32 s52, s52, s53
buffer_load_dwordx4 v10, s[76:79], s52 offen lds
s_add_u32 m0, m0, 1024
s_nop 0
buffer_load_dwordx4 v11, s[76:79], s52 offen lds
s_add_u32 m0, s50, 45056
s_add_u32 s52, s52, s53
buffer_load_dwordx4 v10, s[76:79], s52 offen lds
s_add_u32 m0, m0, 1024
s_nop 0
buffer_load_dwordx4 v11, s[76:79], s52 offen lds
s_waitcnt vmcnt(32)
s_barrier
s_add_u32 m0, s50, 49152
s_add_u32 s52, s52, s53
buffer_load_dwordx4 v10, s[76:79], s52 offen lds
s_add_u32 m0, m0, 1024
s_nop 0
buffer_load_dwordx4 v11, s[76:79], s52 offen lds
s_add_u32 m0, s50, 53248
s_add_u32 s52, s52, s53
buffer_load_dwordx4 v10, s[76:79], s52 offen lds
s_add_u32 m0, m0, 1024
s_nop 0
buffer_load_dwordx4 v11, s[76:79], s52 offen lds
s_add_u32 m0, s50, 57344
s_add_u32 s52, s52, s53
buffer_load_dwordx4 v10, s[76:79], s52 offen lds
s_add_u32 m0, m0, 1024
s_nop 0
buffer_load_dwordx4 v11, s[76:79], s52 offen lds
s_add_u32 m0, s50, 61440
s_add_u32 s52, s52, s53
buffer_load_dwordx4 v10, s[76:79], s52 offen lds
s_add_u32 m0, m0, 1024
s_nop 0
buffer_load_dwordx4 v11, s[76:79], s52 offen lds
s_add_u32 s54, s54, s58
s_add_u32 s55, s55, s58
s_add_u32 s56, s56, s59
s_add_u32 s57, s57, s59
s_mov_b32 s43, 0
L_dloop1:
s_cmp_lg_u32 s43, 3
s_cbranch_scc1 L_dl1
s_add_u32 s54, s54, 131072
s_add_u32 s55, s55, 131072
s_add_u32 s56, s56, 512
s_add_u32 s57, s57, 512
L_dl1:
s_waitcnt vmcnt(16)
s_barrier
s_add_u32 m0, s51, 0
s_mov_b32 s60, s56
buffer_load_dwordx4 v8, s[72:75], s60 offen lds
s_add_u32 m0, s51, 2112
s_add_u32 s60, s60, s61
buffer_load_dwordx4 v8, s[72:75], s60 offen lds
s_add_u32 m0, s51, 4224
s_add_u32 s60, s60, s61
buffer_load_dwordx4 v8, s[72:75], s60 offen lds
s_add_u32 m0, s51, 6336
s_add_u32 s60, s60, s61
buffer_load_dwordx4 v8, s[72:75], s60 offen lds
s_add_u32 m0, s51, 8448
s_add_u32 s60, s60, s61
buffer_load_dwordx4 v9, s[72:75], s60 offen lds
s_add_u32 m0, s51, 10560
s_add_u32 s60, s60, s61
buffer_load_dwordx4 v9, s[72:75], s60 offen lds
s_add_u32 m0, s51, 12672
s_add_u32 s60, s60, s61
buffer_load_dwordx4 v9, s[72:75], s60 offen lds
s_add_u32 m0, s51, 14784
s_add_u32 s60, s60, s61
buffer_load_dwordx4 v9, s[72:75], s60 offen lds
s_add_u32 m0, s51, 16896
s_add_u32 s60, s60, s61
buffer_load_dwordx4 v8, s[72:75], s60 offen lds
s_add_u32 m0, s51, 19008
s_add_u32 s60, s60, s61
buffer_load_dwordx4 v8, s[72:75], s60 offen lds
s_add_u32 m0, s51, 21120
s_add_u32 s60, s60, s61
buffer_load_dwordx4 v8, s[72:75], s60 offen lds
s_add_u32 m0, s51, 23232
s_add_u32 s60, s60, s61
buffer_load_dwordx4 v8, s[72:75], s60 offen lds
s_add_u32 m0, s51, 25344
s_add_u32 s60, s60, s61
buffer_load_dwordx4 v9, s[72:75], s60 offen lds
s_add_u32 m0, s51, 27456
s_add_u32 s60, s60, s61
buffer_load_dwordx4 v9, s[72:75], s60 offen lds
s_add_u32 m0, s51, 29568
s_add_u32 s60, s60, s61
buffer_load_dwordx4 v9, s[72:75], s60 offen lds
s_add_u32 m0, s51, 31680
s_add_u32 s60, s60, s61
buffer_load_dwordx4 v9, s[72:75], s60 offen lds
s_cmp_lg_u32 s41, 0
s_cbranch_scc1 L_sk3
s_add_u32 m0, s51, 33792
s_add_u32 s60, s60, s61
buffer_load_dwordx4 v8, s[72:75], s60 offen lds
L_sk3:
s_add_u32 m0, s50, 0
s_mov_b32 s52, s54
buffer_load_dwordx4 v10, s[76:79], s52 offen lds
s_add_u32 m0, m0, 1024
s_nop 0
buffer_load_dwordx4 v11, s[76:79], s52 offen lds
s_add_u32 m0, s50, 4096
s_add_u32 s52, s52, s53
buffer_load_dwordx4 v10, s[76:79], s52 offen lds
s_add_u32 m0, m0, 1024
s_nop 0
buffer_load_dwordx4 v11, s[76:79], s52 offen lds
s_add_u32 m0, s50, 8192
s_add_u32 s52, s52, s53
buffer_load_dwordx4 v10, s[76:79], s52 offen lds
s_add_u32 m0, m0, 1024
s_nop 0
buffer_load_dwordx4 v11, s[76:79], s52 offen lds
s_add_u32 m0, s50, 12288
s_add_u32 s52, s52, s53
buffer_load_dwordx4 v10, s[76:79], s52 offen lds
s_add_u32 m0, m0, 1024
s_nop 0
buffer_load_dwordx4 v11, s[76:79], s52 offen lds
s_waitcnt vmcnt(32)
s_barrier
s_add_u32 m0, s50, 16384
s_add_u32 s52, s52, s53
buffer_load_dwordx4 v10, s[76:79], s52 offen lds
s_add_u32 m0, m0, 1024
s_nop 0
buffer_load_dwordx4 v11, s[76:79], s52 offen lds
s_add_u32 m0, s50, 20480
s_add_u32 s52, s52, s53
buffer_load_dwordx4 v10, s[76:79], s52 offen lds
s_add_u32 m0, m0, 1024
s_nop 0
buffer_load_dwordx4 v11, s[76:79], s52 offen lds
s_add_u32 m0, s50, 24576
s_add_u32 s52, s52, s53
buffer_load_dwordx4 v10, s[76:79], s52 offen lds
s_add_u32 m0, m0, 1024
s_nop 0
buffer_load_dwordx4 v11, s[76:79], s52 offen lds
s_add_u32 m0, s50, 28672
s_add_u32 s52, s52, s53
buffer_load_dwordx4 v10, s[76:79], s52 offen lds
s_add_u32 m0, m0, 1024
s_nop 0
buffer_load_dwordx4 v11, s[76:79], s52 offen lds
s_waitcnt vmcnt(16)
s_barrier
s_add_u32 m0, s51, 34816
s_mov_b32 s60, s57
buffer_load_dwordx4 v8, s[72:75], s60 offen lds
s_add_u32 m0, s51, 36928
s_add_u32 s60, s60, s61
buffer_load_dwordx4 v8, s[72:75], s60 offen lds
s_add_u32 m0, s51, 39040
s_add_u32 s60, s60, s61
buffer_load_dwordx4 v8, s[72:75], s60 offen lds
s_add_u32 m0, s51, 41152
s_add_u32 s60, s60, s61
buffer_load_dwordx4 v8, s[72:75], s60 offen lds
s_add_u32 m0, s51, 43264
s_add_u32 s60, s60, s61
buffer_load_dwordx4 v9, s[72:75], s60 offen lds
s_add_u32 m0, s51, 45376
s_add_u32 s60, s60, s61
buffer_load_dwordx4 v9, s[72:75], s60 offen lds
s_add_u32 m0, s51, 47488
s_add_u32 s60, s60, s61
buffer_load_dwordx4 v9, s[72:75], s60 offen lds
s_add_u32 m0, s51, 49600
s_add_u32 s60, s60, s61
buffer_load_dwordx4 v9, s[72:75], s60 offen lds
s_add_u32 m0, s51, 51712
s_add_u32 s60, s60, s61
buffer_load_dwordx4 v8, s[72:75], s60 offen lds
s_add_u32 m0, s51, 53824
s_add_u32 s60, s60, s61
buffer_load_dwordx4 v8, s[72:75], s60 offen lds
s_add_u32 m0, s51, 55936
s_add_u32 s60, s60, s61
buffer_load_dwordx4 v8, s[72:75], s60 offen lds
s_add_u32 m0, s51, 58048
s_add_u32 s60, s60, s61
buffer_load_dwordx4 v8, s[72:75], s60 offen lds
s_add_u32 m0, s51, 60160
s_add_u32 s60, s60, s61
buffer_load_dwordx4 v9, s[72:75], s60 offen lds
s_add_u32 m0, s51, 62272
s_add_u32 s60, s60, s61
buffer_load_dwordx4 v9, s[72:75], s60 offen lds
s_add_u32 m0, s51, 64384
s_add_u32 s60, s60, s61
buffer_load_dwordx4 v9, s[72:75], s60 offen lds
s_add_u32 m0, s51, 66496
s_add_u32 s60, s60, s61
buffer_load_dwordx4 v9, s[72:75], s60 offen lds
s_cmp_lg_u32 s41, 0
s_cbranch_scc1 L_sk4
s_add_u32 m0, s51, 68608
s_add_u32 s60, s60, s61
buffer_load_dwordx4 v8, s[72:75], s60 offen lds
L_sk4:
s_add_u32 m0, s50, 32768
s_mov_b32 s52, s55
buffer_load_dwordx4 v10, s[76:79], s52 offen lds
s_add_u32 m0, m0, 1024
s_nop 0
buffer_load_dwordx4 v11, s[76:79], s52 offen lds
s_add_u32 m0, s50, 36864
s_add_u32 s52, s52, s53
buffer_load_dwordx4 v10, s[76:79], s52 offen lds
s_add_u32 m0, m0, 1024
s_nop 0
buffer_load_dwordx4 v11, s[76:79], s52 offen lds
s_add_u32 m0, s50, 40960
s_add_u32 s52, s52, s53
buffer_load_dwordx4 v10, s[76:79], s52 offen lds
s_add_u32 m0, m0, 1024
s_nop 0
buffer_load_dwordx4 v11, s[76:79], s52 offen lds
s_add_u32 m0, s50, 45056
s_add_u32 s52, s52, s53
buffer_load_dwordx4 v10, s[76:79], s52 offen lds
s_add_u32 m0, m0, 1024
s_nop 0
buffer_load_dwordx4 v11, s[76:79], s52 offen lds
s_waitcnt vmcnt(32)
s_barrier
s_add_u32 m0, s50, 49152
s_add_u32 s52, s52, s53
buffer_load_dwordx4 v10, s[76:79], s52 offen lds
s_add_u32 m0, m0, 1024
s_nop 0
buffer_load_dwordx4 v11, s[76:79], s52 offen lds
s_add_u32 m0, s50, 53248
s_add_u32 s52, s52, s53
buffer_load_dwordx4 v10, s[76:79], s52 offen lds
s_add_u32 m0, m0, 1024
s_nop 0
buffer_load_dwordx4 v11, s[76:79], s52 offen lds
s_add_u32 m0, s50, 57344
s_add_u32 s52, s52, s53
buffer_load_dwordx4 v10, s[76:79], s52 offen lds
s_add_u32 m0, m0, 1024
s_nop 0
buffer_load_dwordx4 v11, s[76:79], s52 offen lds
s_add_u32 m0, s50, 61440
s_add_u32 s52, s52, s53
buffer_load_dwordx4 v10, s[76:79], s52 offen lds
s_add_u32 m0, m0, 1024
s_nop 0
buffer_load_dwordx4 v11, s[76:79], s52 offen lds
s_add_u32 s54, s54, s58
s_add_u32 s55, s55, s58
s_add_u32 s56, s56, s59
s_add_u32 s57, s57, s59
s_add_u32 s43, s43, 1
s_cmp_lt_u32 s43, 7
s_cbranch_scc1 L_dloop1
s_mov_b32 s72, s16
s_and_b32 s73, s17, 0xffff
s_mov_b32 s74, 16777216
s_mov_b32 s76, s72
s_mov_b32 s77, s73
s_mov_b32 s78, s74
v_lshlrev_b32 v10, 4, v238
s_lshl_b32 s45, s41, 10
v_add_u32 v8, s45, v10
v_add_u32 v9, s45, v10
v_add_u32 v11, 1024, v10
s_lshl_b32 s46, s37, 4
s_or_b32 s46, s46, s38
s_mul_i32 s56, s46, 278528
s_add_u32 s56, s56, 4194304
s_add_u32 s57, s56, 139264
s_mov_b32 s59, 34816
s_mov_b32 s61, 2048
s_lshl_b32 s54, s39, 18
s_lshl_b32 s45, s41, 17
s_add_u32 s54, s54, s45
s_add_u32 s54, s54, 1048576
s_add_u32 s55, s54, 16384
s_mov_b32 s58, 32768
s_mov_b32 s53, 2048
L_dloop2:
s_waitcnt vmcnt(16)
s_barrier
s_add_u32 m0, s51, 0
s_mov_b32 s60, s56
buffer_load_dwordx4 v8, s[72:75], s60 offen sc1 lds
s_add_u32 m0, s51, 2112
s_add_u32 s60, s60, s61
buffer_load_dwordx4 v8, s[72:75], s60 offen sc1 lds
s_add_u32 m0, s51, 4224
s_add_u32 s60, s60, s61
buffer_load_dwordx4 v8, s[72:75], s60 offen sc1 lds
s_add_u32 m0, s51, 6336
s_add_u32 s60, s60, s61
buffer_load_dwordx4 v8, s[72:75], s60 offen sc1 lds
s_add_u32 m0, s51, 8448
s_add_u32 s60, s60, s61
buffer_load_dwordx4 v9, s[72:75], s60 offen sc1 lds
s_add_u32 m0, s51, 10560
s_add_u32 s60, s60, s61
buffer_load_dwordx4 v9, s[72:75], s60 offen sc1 lds
s_add_u32 m0, s51, 12672
s_add_u32 s60, s60, s61
buffer_load_dwordx4 v9, s[72:75], s60 offen sc1 lds
s_add_u32 m0, s51, 14784
s_add_u32 s60, s60, s61
buffer_load_dwordx4 v9, s[72:75], s60 offen sc1 lds
s_add_u32 m0, s51, 16896
s_add_u32 s60, s60, s61
buffer_load_dwordx4 v8, s[72:75], s60 offen sc1 lds
s_add_u32 m0, s51, 19008
s_add_u32 s60, s60, s61
buffer_load_dwordx4 v8, s[72:75], s60 offen sc1 lds
s_add_u32 m0, s51, 21120
s_add_u32 s60, s60, s61
buffer_load_dwordx4 v8, s[72:75], s60 offen sc1 lds
s_add_u32 m0, s51, 23232
s_add_u32 s60, s60, s61
buffer_load_dwordx4 v8, s[72:75], s60 offen sc1 lds
s_add_u32 m0, s51, 25344
s_add_u32 s60, s60, s61
buffer_load_dwordx4 v9, s[72:75], s60 offen sc1 lds
s_add_u32 m0, s51, 27456
s_add_u32 s60, s60, s61
buffer_load_dwordx4 v9, s[72:75], s60 offen sc1 lds
s_add_u32 m0, s51, 29568
s_add_u32 s60, s60, s61
buffer_load_dwordx4 v9, s[72:75], s60 offen sc1 lds
s_add_u32 m0, s51, 31680
s_add_u32 s60, s60, s61
buffer_load_dwordx4 v9, s[72:75], s60 offen sc1 lds
s_cmp_lg_u32 s41, 0
s_cbranch_scc1 L_sk5
s_add_u32 m0, s51, 33792
s_add_u32 s60, s60, s61
buffer_load_dwordx4 v8, s[72:75], s60 offen sc1 lds
L_sk5:
s_add_u32 m0, s50, 0
s_mov_b32 s52, s54
buffer_load_dwordx4 v10, s[76:79], s52 offen sc1 lds
s_add_u32 m0, m0, 1024
s_nop 0
buffer_load_dwordx4 v11, s[76:79], s52 offen sc1 lds
s_add_u32 m0, s50, 4096
s_add_u32 s52, s52, s53
buffer_load_dwordx4 v10, s[76:79], s52 offen sc1 lds
s_add_u32 m0, m0, 1024
s_nop 0
buffer_load_dwordx4 v11, s[76:79], s52 offen sc1 lds
s_add_u32 m0, s50, 8192
s_add_u32 s52, s52, s53
buffer_load_dwordx4 v10, s[76:79], s52 offen sc1 lds
s_add_u32 m0, m0, 1024
s_nop 0
buffer_load_dwordx4 v11, s[76:79], s52 offen sc1 lds
s_add_u32 m0, s50, 12288
s_add_u32 s52, s52, s53
buffer_load_dwordx4 v10, s[76:79], s52 offen sc1 lds
s_add_u32 m0, m0, 1024
s_nop 0
buffer_load_dwordx4 v11, s[76:79], s52 offen sc1 lds
s_waitcnt vmcnt(32)
s_barrier
s_add_u32 m0, s50, 16384
s_add_u32 s52, s52, s53
buffer_load_dwordx4 v10, s[76:79], s52 offen sc1 lds
s_add_u32 m0, m0, 1024
s_nop 0
buffer_load_dwordx4 v11, s[76:79], s52 offen sc1 lds
s_add_u32 m0, s50, 20480
s_add_u32 s52, s52, s53
buffer_load_dwordx4 v10, s[76:79], s52 offen sc1 lds
s_add_u32 m0, m0, 1024
s_nop 0
buffer_load_dwordx4 v11, s[76:79], s52 offen sc1 lds
s_add_u32 m0, s50, 24576
s_add_u32 s52, s52, s53
buffer_load_dwordx4 v10, s[76:79], s52 offen sc1 lds
s_add_u32 m0, m0, 1024
s_nop 0
buffer_load_dwordx4 v11, s[76:79], s52 offen sc1 lds
s_add_u32 m0, s50, 28672
s_add_u32 s52, s52, s53
buffer_load_dwordx4 v10, s[76:79], s52 offen sc1 lds
s_add_u32 m0, m0, 1024
s_nop 0
buffer_load_dwordx4 v11, s[76:79], s52 offen sc1 lds
s_waitcnt vmcnt(16)
s_barrier
s_add_u32 m0, s51, 34816
s_mov_b32 s60, s57
buffer_load_dwordx4 v8, s[72:75], s60 offen sc1 lds
s_add_u32 m0, s51, 36928
s_add_u32 s60, s60, s61
buffer_load_dwordx4 v8, s[72:75], s60 offen sc1 lds
s_add_u32 m0, s51, 39040
s_add_u32 s60, s60, s61
buffer_load_dwordx4 v8, s[72:75], s60 offen sc1 lds
s_add_u32 m0, s51, 41152
s_add_u32 s60, s60, s61
buffer_load_dwordx4 v8, s[72:75], s60 offen sc1 lds
s_add_u32 m0, s51, 43264
s_add_u32 s60, s60, s61
buffer_load_dwordx4 v9, s[72:75], s60 offen sc1 lds
s_add_u32 m0, s51, 45376
s_add_u32 s60, s60, s61
buffer_load_dwordx4 v9, s[72:75], s60 offen sc1 lds
s_add_u32 m0, s51, 47488
s_add_u32 s60, s60, s61
buffer_load_dwordx4 v9, s[72:75], s60 offen sc1 lds
s_add_u32 m0, s51, 49600
s_add_u32 s60, s60, s61
buffer_load_dwordx4 v9, s[72:75], s60 offen sc1 lds
s_add_u32 m0, s51, 51712
s_add_u32 s60, s60, s61
buffer_load_dwordx4 v8, s[72:75], s60 offen sc1 lds
s_add_u32 m0, s51, 53824
s_add_u32 s60, s60, s61
buffer_load_dwordx4 v8, s[72:75], s60 offen sc1 lds
s_add_u32 m0, s51, 55936
s_add_u32 s60, s60, s61
buffer_load_dwordx4 v8, s[72:75], s60 offen sc1 lds
s_add_u32 m0, s51, 58048
s_add_u32 s60, s60, s61
buffer_load_dwordx4 v8, s[72:75], s60 offen sc1 lds
s_add_u32 m0, s51, 60160
s_add_u32 s60, s60, s61
buffer_load_dwordx4 v9, s[72:75], s60 offen sc1 lds
s_add_u32 m0, s51, 62272
s_add_u32 s60, s60, s61
buffer_load_dwordx4 v9, s[72:75], s60 offen sc1 lds
s_add_u32 m0, s51, 64384
s_add_u32 s60, s60, s61
buffer_load_dwordx4 v9, s[72:75], s60 offen sc1 lds
s_add_u32 m0, s51, 66496
s_add_u32 s60, s60, s61
buffer_load_dwordx4 v9, s[72:75], s60 offen sc1 lds
s_cmp_lg_u32 s41, 0
s_cbranch_scc1 L_sk6
s_add_u32 m0, s51, 68608
s_add_u32 s60, s60, s61
buffer_load_dwordx4 v8, s[72:75], s60 offen sc1 lds
L_sk6:
s_add_u32 m0, s50, 32768
s_mov_b32 s52, s55
buffer_load_dwordx4 v10, s[76:79], s52 offen sc1 lds
s_add_u32 m0, m0, 1024
s_nop 0
buffer_load_dwordx4 v11, s[76:79], s52 offen sc1 lds
s_add_u32 m0, s50, 36864
s_add_u32 s52, s52, s53
buffer_load_dwordx4 v10, s[76:79], s52 offen sc1 lds
s_add_u32 m0, m0, 1024
s_nop 0
buffer_load_dwordx4 v11, s[76:79], s52 offen sc1 lds
s_add_u32 m0, s50, 40960
s_add_u32 s52, s52, s53
buffer_load_dwordx4 v10, s[76:79], s52 offen sc1 lds
s_add_u32 m0, m0, 1024
s_nop 0
buffer_load_dwordx4 v11, s[76:79], s52 offen sc1 lds
s_add_u32 m0, s50, 45056
s_add_u32 s52, s52, s53
buffer_load_dwordx4 v10, s[76:79], s52 offen sc1 lds
s_add_u32 m0, m0, 1024
s_nop 0
buffer_load_dwordx4 v11, s[76:79], s52 offen sc1 lds
s_waitcnt vmcnt(32)
s_barrier
s_add_u32 m0, s50, 49152
s_add_u32 s52, s52, s53
buffer_load_dwordx4 v10, s[76:79], s52 offen sc1 lds
s_add_u32 m0, m0, 1024
s_nop 0
buffer_load_dwordx4 v11, s[76:79], s52 offen sc1 lds
s_add_u32 m0, s50, 53248
s_add_u32 s52, s52, s53
buffer_load_dwordx4 v10, s[76:79], s52 offen sc1 lds
s_add_u32 m0, m0, 1024
s_nop 0
buffer_load_dwordx4 v11, s[76:79], s52 offen sc1 lds
s_add_u32 m0, s50, 57344
s_add_u32 s52, s52, s53
buffer_load_dwordx4 v10, s[76:79], s52 offen sc1 lds
s_add_u32 m0, m0, 1024
s_nop 0
buffer_load_dwordx4 v11, s[76:79], s52 offen sc1 lds
s_add_u32 m0, s50, 61440
s_add_u32 s52, s52, s53
buffer_load_dwordx4 v10, s[76:79], s52 offen sc1 lds
s_add_u32 m0, m0, 1024
s_nop 0
buffer_load_dwordx4 v11, s[76:79], s52 offen sc1 lds
s_add_u32 s54, s54, s58
s_add_u32 s55, s55, s58
s_add_u32 s56, s56, s59
s_add_u32 s57, s57, s59
s_add_u32 s43, s43, 1
s_cmp_lt_u32 s43, 11
s_cbranch_scc1 L_dloop2
s_waitcnt vmcnt(16)
s_barrier
s_waitcnt vmcnt(8)
s_barrier
s_waitcnt vmcnt(0)
s_barrier
s_endpgm
L_trans:
s_lshl_b32 s46, s41, 9
s_add_u32 s45, s45, s46
s_add_u32 s45, s45, 1024
v_lshrrev_b32 v1, 3, v238
v_and_b32 v2, 7, v238
v_lshlrev_b32 v2, 4, v2
v_lshl_add_u32 v2, v1, 11, v2
v_add_u32 v13, s45, v2
v_lshrrev_b32 v1, 5, v238
v_lshlrev_b32 v12, 4, v238
s_lshr_b32 s47, s2, 5
s_lshl_b32 s66, s47, 19
s_lshl_b32 s67, s47, 11
s_bfe_u32 s47, s2, 0x10004
s_lshl_b32 s48, s47, 17
s_add_u32 s66, s66, s48
s_lshl_b32 s48, s47, 14
s_add_u32 s67, s67, s48
s_and_b32 s47, s2, 15
s_lshl_b32 s47, s47, 11
s_add_u32 s66, s66, s47
s_lshl_b32 s47, s41, 10
s_add_u32 s66, s66, s47
s_waitcnt lgkmcnt(0)
s_mov_b32 s76, s74
s_and_b32 s77, s75, 0xffff
s_mov_b32 s78, 4063232
s_mov_b32 s79, 0x00020000
s_and_b32 s73, s73, 0xffff
s_mov_b32 s74, 16384000
s_mov_b32 s75, 0x00020000
s_barrier
s_add_u32 s46, s39, 32
s_mul_i32 s47, s46, 241
s_lshr_b32 s47, s47, 13
s_mul_i32 s48, s47, 34
s_sub_u32 s46, s46, s48
s_lshl_b32 s45, s46, 14
s_lshl_b32 s47, s47, 7
s_add_u32 s45, s45, s47
s_add_u32 s45, s45, 1024
buffer_load_dwordx4 v[64:67], v13, s[72:75], s45 offen
s_add_u32 s46, s39, 40
s_mul_i32 s47, s46, 241
s_lshr_b32 s47, s47, 13
s_mul_i32 s48, s47, 34
s_sub_u32 s46, s46, s48
s_lshl_b32 s45, s46, 14
s_lshl_b32 s47, s47, 7
s_add_u32 s45, s45, s47
s_add_u32 s45, s45, 1024
buffer_load_dwordx4 v[72:75], v13, s[72:75], s45 offen
s_add_u32 s46, s39, 48
s_mul_i32 s47, s46, 241
s_lshr_b32 s47, s47, 13
s_mul_i32 s48, s47, 34
s_sub_u32 s46, s46, s48
s_lshl_b32 s45, s46, 14
s_lshl_b32 s47, s47, 7
s_add_u32 s45, s45, s47
s_add_u32 s45, s45, 1024
buffer_load_dwordx4 v[80:83], v13, s[72:75], s45 offen
s_add_u32 s46, s39, 56
s_mul_i32 s47, s46, 241
s_lshr_b32 s47, s47, 13
s_mul_i32 s48, s47, 34
s_sub_u32 s46, s46, s48
s_lshl_b32 s45, s46, 14
s_lshl_b32 s47, s47, 7
s_add_u32 s45, s45, s47
s_add_u32 s45, s45, 1024
buffer_load_dwordx4 v[88:91], v13, s[72:75], s45 offen
s_add_u32 s46, s39, 64
s_mul_i32 s47, s46, 241
s_lshr_b32 s47, s47, 13
s_mul_i32 s48, s47, 34
s_sub_u32 s46, s46, s48
s_lshl_b32 s45, s46, 14
s_lshl_b32 s47, s47, 7
s_add_u32 s45, s45, s47
s_add_u32 s45, s45, 1024
buffer_load_dwordx4 v[96:99], v13, s[72:75], s45 offen
s_and_b32 s17, s17, 0xffff
s_mov_b32 s18, 16777216
s_mov_b32 s19, 0x00020000
s_and_b32 s21, s21, 0xffff
s_mov_b32 s22, 256
s_mov_b32 s23, 0x00020000
s_lshl_b32 s40, s37, 4
s_or_b32 s40, s40, s38
s_mov_b32 s65, 0xffff0000
s_lshl_b32 s46, s40, 1
s_add_u32 s46, s46, s41
s_mul_i32 s64, s46, 139264
s_add_u32 s64, s64, 4194304
v_bfe_u32 v2, v238, 2, 3
v_lshlrev_b32 v2, 18, v2
v_lshl_add_u32 v2, v1, 6, v2
v_and_b32 v3, 3, v238
v_lshl_add_u32 v2, v3, 4, v2
s_bfe_u32 s46, s2, 0x10001
s_lshl_b32 s46, s46, 5
v_xor_b32 v9, s46, v2
s_bfe_u32 s47, s2, 0x10003
s_lshl_b32 s47, s47, 17
s_add_u32 s67, s67, s47
s_and_b32 s47, s2, 7
s_lshl_b32 s47, s47, 8
s_add_u32 s67, s67, s47
s_lshl_b32 s47, s41, 7
s_add_u32 s67, s67, s47
s_add_u32 s67, s67, 1048576
s_lshl_b32 s49, s37, 3
s_or_b32 s49, s49, s39
s_lshl_b32 s49, s49, 13
s_lshl_b32 s47, s41, 4
s_add_u32 s47, s47, s38
s_lshl_b32 s47, s47, 7
s_add_u32 s47, s47, s49
v_and_b32 v6, 31, v238
v_lshlrev_b32 v6, 2, v6
v_lshl_add_u32 v6, v1, 12, v6
v_mov_b32 v7, -1
s_barrier
buffer_store_dword v7, v6, s[16:19], s47 offen sc1
s_add_u32 s45, s66, 32768
buffer_load_dwordx4 v[176:179], v12, s[76:79], s45 offen
s_add_u32 s46, s39, 72
s_mul_i32 s47, s46, 241
s_lshr_b32 s47, s47, 13
s_mul_i32 s48, s47, 34
s_sub_u32 s46, s46, s48
s_lshl_b32 s45, s46, 14
s_lshl_b32 s47, s47, 7
s_add_u32 s45, s45, s47
s_add_u32 s45, s45, 1024
buffer_load_dwordx4 v[104:107], v13, s[72:75], s45 offen
s_add_u32 s46, s39, 80
s_mul_i32 s47, s46, 241
s_lshr_b32 s47, s47, 13
s_mul_i32 s48, s47, 34
s_sub_u32 s46, s46, s48
s_lshl_b32 s45, s46, 14
s_lshl_b32 s47, s47, 7
s_add_u32 s45, s45, s47
s_add_u32 s45, s45, 1024
buffer_load_dwordx4 v[112:115], v13, s[72:75], s45 offen
s_add_u32 s46, s39, 88
s_mul_i32 s47, s46, 241
s_lshr_b32 s47, s47, 13
s_mul_i32 s48, s47, 34
s_sub_u32 s46, s46, s48
s_lshl_b32 s45, s46, 14
s_lshl_b32 s47, s47, 7
s_add_u32 s45, s45, s47
s_add_u32 s45, s45, 1024
buffer_load_dwordx4 v[120:123], v13, s[72:75], s45 offen
s_add_u32 s46, s39, 96
s_mul_i32 s47, s46, 241
s_lshr_b32 s47, s47, 13
s_mul_i32 s48, s47, 34
s_sub_u32 s46, s46, s48
s_lshl_b32 s45, s46, 14
s_lshl_b32 s47, s47, 7
s_add_u32 s45, s45, s47
s_add_u32 s45, s45, 1024
buffer_load_dwordx4 v[128:131], v13, s[72:75], s45 offen
s_barrier
s_add_u32 s45, s66, 65536
buffer_load_dwordx4 v[184:187], v12, s[76:79], s45 offen
s_add_u32 s45, s66, 98304
buffer_load_dwordx4 v[192:195], v12, s[76:79], s45 offen
s_add_u32 s46, s39, 104
s_mul_i32 s47, s46, 241
s_lshr_b32 s47, s47, 13
s_mul_i32 s48, s47, 34
s_sub_u32 s46, s46, s48
s_lshl_b32 s45, s46, 14
s_lshl_b32 s47, s47, 7
s_add_u32 s45, s45, s47
s_add_u32 s45, s45, 1024
buffer_load_dwordx4 v[136:139], v13, s[72:75], s45 offen
s_add_u32 s46, s39, 112
s_mul_i32 s47, s46, 241
s_lshr_b32 s47, s47, 13
s_mul_i32 s48, s47, 34
s_sub_u32 s46, s46, s48
s_lshl_b32 s45, s46, 14
s_lshl_b32 s47, s47, 7
s_add_u32 s45, s45, s47
s_add_u32 s45, s45, 1024
buffer_load_dwordx4 v[144:147], v13, s[72:75], s45 offen
s_add_u32 s46, s39, 120
s_mul_i32 s47, s46, 241
s_lshr_b32 s47, s47, 13
s_mul_i32 s48, s47, 34
s_sub_u32 s46, s46, s48
s_lshl_b32 s45, s46, 14
s_lshl_b32 s47, s47, 7
s_add_u32 s45, s45, s47
s_add_u32 s45, s45, 1024
buffer_load_dwordx4 v[152:155], v13, s[72:75], s45 offen
s_barrier
s_add_u32 s46, s39, 128
s_mul_i32 s47, s46, 241
s_lshr_b32 s47, s47, 13
s_mul_i32 s48, s47, 34
s_sub_u32 s46, s46, s48
s_lshl_b32 s45, s46, 14
s_lshl_b32 s47, s47, 7
s_add_u32 s45, s45, s47
s_add_u32 s45, s45, 1024
buffer_load_dwordx4 v[160:163], v13, s[72:75], s45 offen
s_add_u32 s45, s66, 262144
buffer_load_dwordx4 v[172:175], v12, s[76:79], s45 offen
s_add_u32 s45, s66, 294912
buffer_load_dwordx4 v[180:183], v12, s[76:79], s45 offen
s_add_u32 s45, s66, 327680
buffer_load_dwordx4 v[188:191], v12, s[76:79], s45 offen
s_add_u32 s45, s66, 360448
buffer_load_dwordx4 v[196:199], v12, s[76:79], s45 offen
s_barrier
s_add_u32 s46, s39, 0
s_mul_i32 s47, s46, 241
s_lshr_b32 s47, s47, 13
s_mul_i32 s48, s47, 34
s_sub_u32 s46, s46, s48
s_lshl_b32 s45, s46, 14
s_lshl_b32 s47, s47, 7
s_add_u32 s45, s45, s47
buffer_load_dwordx4 v[36:39], v13, s[72:75], s45 offen
s_add_u32 s46, s39, 8
s_mul_i32 s47, s46, 241
s_lshr_b32 s47, s47, 13
s_mul_i32 s48, s47, 34
s_sub_u32 s46, s46, s48
s_lshl_b32 s45, s46, 14
s_lshl_b32 s47, s47, 7
s_add_u32 s45, s45, s47
buffer_load_dwordx4 v[44:47], v13, s[72:75], s45 offen
s_add_u32 s46, s39, 16
s_mul_i32 s47, s46, 241
s_lshr_b32 s47, s47, 13
s_mul_i32 s48, s47, 34
s_sub_u32 s46, s46, s48
s_lshl_b32 s45, s46, 14
s_lshl_b32 s47, s47, 7
s_add_u32 s45, s45, s47
buffer_load_dwordx4 v[52:55], v13, s[72:75], s45 offen
s_add_u32 s46, s39, 24
s_mul_i32 s47, s46, 241
s_lshr_b32 s47, s47, 13
s_mul_i32 s48, s47, 34
s_sub_u32 s46, s46, s48
s_lshl_b32 s45, s46, 14
s_lshl_b32 s47, s47, 7
s_add_u32 s45, s45, s47
buffer_load_dwordx4 v[60:63], v13, s[72:75], s45 offen
s_add_u32 s46, s39, 32
s_mul_i32 s47, s46, 241
s_lshr_b32 s47, s47, 13
s_mul_i32 s48, s47, 34
s_sub_u32 s46, s46, s48
s_lshl_b32 s45, s46, 14
s_lshl_b32 s47, s47, 7
s_add_u32 s45, s45, s47
buffer_load_dwordx4 v[68:71], v13, s[72:75], s45 offen
s_barrier
s_add_u32 s46, s39, 40
s_mul_i32 s47, s46, 241
s_lshr_b32 s47, s47, 13
s_mul_i32 s48, s47, 34
s_sub_u32 s46, s46, s48
s_lshl_b32 s45, s46, 14
s_lshl_b32 s47, s47, 7
s_add_u32 s45, s45, s47
buffer_load_dwordx4 v[76:79], v13, s[72:75], s45 offen
s_add_u32 s46, s39, 48
s_mul_i32 s47, s46, 241
s_lshr_b32 s47, s47, 13
s_mul_i32 s48, s47, 34
s_sub_u32 s46, s46, s48
s_lshl_b32 s45, s46, 14
s_lshl_b32 s47, s47, 7
s_add_u32 s45, s45, s47
buffer_load_dwordx4 v[84:87], v13, s[72:75], s45 offen
s_add_u32 s46, s39, 56
s_mul_i32 s47, s46, 241
s_lshr_b32 s47, s47, 13
s_mul_i32 s48, s47, 34
s_sub_u32 s46, s46, s48
s_lshl_b32 s45, s46, 14
s_lshl_b32 s47, s47, 7
s_add_u32 s45, s45, s47
buffer_load_dwordx4 v[92:95], v13, s[72:75], s45 offen
s_add_u32 s46, s39, 64
s_mul_i32 s47, s46, 241
s_lshr_b32 s47, s47, 13
s_mul_i32 s48, s47, 34
s_sub_u32 s46, s46, s48
s_lshl_b32 s45, s46, 14
s_lshl_b32 s47, s47, 7
s_add_u32 s45, s45, s47
buffer_load_dwordx4 v[100:103], v13, s[72:75], s45 offen
s_add_u32 s46, s39, 72
s_mul_i32 s47, s46, 241
s_lshr_b32 s47, s47, 13
s_mul_i32 s48, s47, 34
s_sub_u32 s46, s46, s48
s_lshl_b32 s45, s46, 14
s_lshl_b32 s47, s47, 7
s_add_u32 s45, s45, s47
buffer_load_dwordx4 v[108:111], v13, s[72:75], s45 offen
s_barrier
s_add_u32 s46, s39, 80
s_mul_i32 s47, s46, 241
s_lshr_b32 s47, s47, 13
s_mul_i32 s48, s47, 34
s_sub_u32 s46, s46, s48
s_lshl_b32 s45, s46, 14
s_lshl_b32 s47, s47, 7
s_add_u32 s45, s45, s47
buffer_load_dwordx4 v[116:119], v13, s[72:75], s45 offen
s_add_u32 s46, s39, 88
s_mul_i32 s47, s46, 241
s_lshr_b32 s47, s47, 13
s_mul_i32 s48, s47, 34
s_sub_u32 s46, s46, s48
s_lshl_b32 s45, s46, 14
s_lshl_b32 s47, s47, 7
s_add_u32 s45, s45, s47
buffer_load_dwordx4 v[124:127], v13, s[72:75], s45 offen
s_add_u32 s46, s39, 96
s_mul_i32 s47, s46, 241
s_lshr_b32 s47, s47, 13
s_mul_i32 s48, s47, 34
s_sub_u32 s46, s46, s48
s_lshl_b32 s45, s46, 14
s_lshl_b32 s47, s47, 7
s_add_u32 s45, s45, s47
buffer_load_dwordx4 v[132:135], v13, s[72:75], s45 offen
s_add_u32 s46, s39, 104
s_mul_i32 s47, s46, 241
s_lshr_b32 s47, s47, 13
s_mul_i32 s48, s47, 34
s_sub_u32 s46, s46, s48
s_lshl_b32 s45, s46, 14
s_lshl_b32 s47, s47, 7
s_add_u32 s45, s45, s47
buffer_load_dwordx4 v[140:143], v13, s[72:75], s45 offen
s_add_u32 s46, s39, 112
s_mul_i32 s47, s46, 241
s_lshr_b32 s47, s47, 13
s_mul_i32 s48, s47, 34
s_sub_u32 s46, s46, s48
s_lshl_b32 s45, s46, 14
s_lshl_b32 s47, s47, 7
s_add_u32 s45, s45, s47
buffer_load_dwordx4 v[148:151], v13, s[72:75], s45 offen
s_barrier
s_add_u32 s46, s39, 120
s_mul_i32 s47, s46, 241
s_lshr_b32 s47, s47, 13
s_mul_i32 s48, s47, 34
s_sub_u32 s46, s46, s48
s_lshl_b32 s45, s46, 14
s_lshl_b32 s47, s47, 7
s_add_u32 s45, s45, s47
buffer_load_dwordx4 v[156:159], v13, s[72:75], s45 offen
s_add_u32 s46, s39, 128
s_mul_i32 s47, s46, 241
s_lshr_b32 s47, s47, 13
s_mul_i32 s48, s47, 34
s_sub_u32 s46, s46, s48
s_lshl_b32 s45, s46, 14
s_lshl_b32 s47, s47, 7
s_add_u32 s45, s45, s47
buffer_load_dwordx4 v[164:167], v13, s[72:75], s45 offen
s_add_u32 s45, s66, 0
buffer_load_dwordx4 v[168:171], v12, s[76:79], s45 offen
s_add_u32 s46, s39, 0
s_mul_i32 s47, s46, 241
s_lshr_b32 s47, s47, 13
s_mul_i32 s48, s47, 34
s_sub_u32 s46, s46, s48
s_lshl_b32 s45, s46, 14
s_lshl_b32 s47, s47, 7
s_add_u32 s45, s45, s47
s_add_u32 s45, s45, 1024
buffer_load_dwordx4 v[32:35], v13, s[72:75], s45 offen
s_add_u32 s46, s39, 8
s_mul_i32 s47, s46, 241
s_lshr_b32 s47, s47, 13
s_mul_i32 s48, s47, 34
s_sub_u32 s46, s46, s48
s_lshl_b32 s45, s46, 14
s_lshl_b32 s47, s47, 7
s_add_u32 s45, s45, s47
s_add_u32 s45, s45, 1024
buffer_load_dwordx4 v[40:43], v13, s[72:75], s45 offen
s_barrier
s_add_u32 s46, s39, 16
s_mul_i32 s47, s46, 241
s_lshr_b32 s47, s47, 13
s_mul_i32 s48, s47, 34
s_sub_u32 s46, s46, s48
s_lshl_b32 s45, s46, 14
s_lshl_b32 s47, s47, 7
s_add_u32 s45, s45, s47
s_add_u32 s45, s45, 1024
buffer_load_dwordx4 v[48:51], v13, s[72:75], s45 offen
s_add_u32 s46, s39, 24
s_mul_i32 s47, s46, 241
s_lshr_b32 s47, s47, 13
s_mul_i32 s48, s47, 34
s_sub_u32 s46, s46, s48
s_lshl_b32 s45, s46, 14
s_lshl_b32 s47, s47, 7
s_add_u32 s45, s45, s47
s_add_u32 s45, s45, 1024
buffer_load_dwordx4 v[56:59], v13, s[72:75], s45 offen
s_barrier
s_barrier
s_barrier
s_waitcnt vmcnt(17)
v_lshlrev_b32 v16, 16, v64
v_lshlrev_b32 v17, 16, v68
v_and_b32 v18, s65, v64
v_and_b32 v19, s65, v68
v_add_f32 v16, v16, v17
v_add_f32 v18, v18, v19
v_cvt_pk_bf16_f32 v20, v16, v18
v_lshlrev_b32 v16, 16, v65
v_lshlrev_b32 v17, 16, v69
v_and_b32 v18, s65, v65
v_and_b32 v19, s65, v69
v_add_f32 v16, v16, v17
v_add_f32 v18, v18, v19
v_cvt_pk_bf16_f32 v21, v16, v18
v_lshlrev_b32 v16, 16, v66
v_lshlrev_b32 v17, 16, v70
v_and_b32 v18, s65, v66
v_and_b32 v19, s65, v70
v_add_f32 v16, v16, v17
v_add_f32 v18, v18, v19
v_cvt_pk_bf16_f32 v22, v16, v18
v_lshlrev_b32 v16, 16, v67
v_lshlrev_b32 v17, 16, v71
v_and_b32 v18, s65, v67
v_and_b32 v19, s65, v71
v_add_f32 v16, v16, v17
v_add_f32 v18, v18, v19
v_cvt_pk_bf16_f32 v23, v16, v18
s_add_u32 s46, s39, 32
s_mul_i32 s47, s46, 241
s_lshr_b32 s47, s47, 13
s_mul_i32 s48, s47, 34
s_sub_u32 s46, s46, s48
s_mul_i32 s45, s47, 34816
s_add_u32 s45, s45, s64
s_and_b32 s47, s46, 8
s_lshl_b32 s47, s47, 2
v_xor_b32 v15, s47, v12
s_lshl_b32 s46, s46, 10
s_add_u32 s45, s45, s46
buffer_store_dwordx4 v[20:23], v15, s[16:19], s45 offen sc1
s_waitcnt vmcnt(17)
v_lshlrev_b32 v16, 16, v72
v_lshlrev_b32 v17, 16, v76
v_and_b32 v18, s65, v72
v_and_b32 v19, s65, v76
v_add_f32 v16, v16, v17
v_add_f32 v18, v18, v19
v_cvt_pk_bf16_f32 v24, v16, v18
v_lshlrev_b32 v16, 16, v73
v_lshlrev_b32 v17, 16, v77
v_and_b32 v18, s65, v73
v_and_b32 v19, s65, v77
v_add_f32 v16, v16, v17
v_add_f32 v18, v18, v19
v_cvt_pk_bf16_f32 v25, v16, v18
v_lshlrev_b32 v16, 16, v74
v_lshlrev_b32 v17, 16, v78
v_and_b32 v18, s65, v74
v_and_b32 v19, s65, v78
v_add_f32 v16, v16, v17
v_add_f32 v18, v18, v19
v_cvt_pk_bf16_f32 v26, v16, v18
v_lshlrev_b32 v16, 16, v75
v_lshlrev_b32 v17, 16, v79
v_and_b32 v18, s65, v75
v_and_b32 v19, s65, v79
v_add_f32 v16, v16, v17
v_add_f32 v18, v18, v19
v_cvt_pk_bf16_f32 v27, v16, v18
s_add_u32 s46, s39, 40
s_mul_i32 s47, s46, 241
s_lshr_b32 s47, s47, 13
s_mul_i32 s48, s47, 34
s_sub_u32 s46, s46, s48
s_mul_i32 s45, s47, 34816
s_add_u32 s45, s45, s64
s_and_b32 s47, s46, 8
s_lshl_b32 s47, s47, 2
v_xor_b32 v15, s47, v12
s_lshl_b32 s46, s46, 10
s_add_u32 s45, s45, s46
buffer_store_dwordx4 v[24:27], v15, s[16:19], s45 offen sc1
s_waitcnt vmcnt(17)
v_lshlrev_b32 v16, 16, v80
v_lshlrev_b32 v17, 16, v84
v_and_b32 v18, s65, v80
v_and_b32 v19, s65, v84
v_add_f32 v16, v16, v17
v_add_f32 v18, v18, v19
v_cvt_pk_bf16_f32 v20, v16, v18
v_lshlrev_b32 v16, 16, v81
v_lshlrev_b32 v17, 16, v85
v_and_b32 v18, s65, v81
v_and_b32 v19, s65, v85
v_add_f32 v16, v16, v17
v_add_f32 v18, v18, v19
v_cvt_pk_bf16_f32 v21, v16, v18
v_lshlrev_b32 v16, 16, v82
v_lshlrev_b32 v17, 16, v86
v_and_b32 v18, s65, v82
v_and_b32 v19, s65, v86
v_add_f32 v16, v16, v17
v_add_f32 v18, v18, v19
v_cvt_pk_bf16_f32 v22, v16, v18
v_lshlrev_b32 v16, 16, v83
v_lshlrev_b32 v17, 16, v87
v_and_b32 v18, s65, v83
v_and_b32 v19, s65, v87
v_add_f32 v16, v16, v17
v_add_f32 v18, v18, v19
v_cvt_pk_bf16_f32 v23, v16, v18
s_add_u32 s46, s39, 48
s_mul_i32 s47, s46, 241
s_lshr_b32 s47, s47, 13
s_mul_i32 s48, s47, 34
s_sub_u32 s46, s46, s48
s_mul_i32 s45, s47, 34816
s_add_u32 s45, s45, s64
s_and_b32 s47, s46, 8
s_lshl_b32 s47, s47, 2
v_xor_b32 v15, s47, v12
s_lshl_b32 s46, s46, 10
s_add_u32 s45, s45, s46
buffer_store_dwordx4 v[20:23], v15, s[16:19], s45 offen sc1
s_barrier
s_waitcnt vmcnt(17)
v_lshlrev_b32 v16, 16, v88
v_lshlrev_b32 v17, 16, v92
v_and_b32 v18, s65, v88
v_and_b32 v19, s65, v92
v_add_f32 v16, v16, v17
v_add_f32 v18, v18, v19
v_cvt_pk_bf16_f32 v24, v16, v18
v_lshlrev_b32 v16, 16, v89
v_lshlrev_b32 v17, 16, v93
v_and_b32 v18, s65, v89
v_and_b32 v19, s65, v93
v_add_f32 v16, v16, v17
v_add_f32 v18, v18, v19
v_cvt_pk_bf16_f32 v25, v16, v18
v_lshlrev_b32 v16, 16, v90
v_lshlrev_b32 v17, 16, v94
v_and_b32 v18, s65, v90
v_and_b32 v19, s65, v94
v_add_f32 v16, v16, v17
v_add_f32 v18, v18, v19
v_cvt_pk_bf16_f32 v26, v16, v18
v_lshlrev_b32 v16, 16, v91
v_lshlrev_b32 v17, 16, v95
v_and_b32 v18, s65, v91
v_and_b32 v19, s65, v95
v_add_f32 v16, v16, v17
v_add_f32 v18, v18, v19
v_cvt_pk_bf16_f32 v27, v16, v18
s_add_u32 s46, s39, 56
s_mul_i32 s47, s46, 241
s_lshr_b32 s47, s47, 13
s_mul_i32 s48, s47, 34
s_sub_u32 s46, s46, s48
s_mul_i32 s45, s47, 34816
s_add_u32 s45, s45, s64
s_and_b32 s47, s46, 8
s_lshl_b32 s47, s47, 2
v_xor_b32 v15, s47, v12
s_lshl_b32 s46, s46, 10
s_add_u32 s45, s45, s46
buffer_store_dwordx4 v[24:27], v15, s[16:19], s45 offen sc1
s_waitcnt vmcnt(17)
v_lshlrev_b32 v16, 16, v96
v_lshlrev_b32 v17, 16, v100
v_and_b32 v18, s65, v96
v_and_b32 v19, s65, v100
v_add_f32 v16, v16, v17
v_add_f32 v18, v18, v19
v_cvt_pk_bf16_f32 v20, v16, v18
v_lshlrev_b32 v16, 16, v97
v_lshlrev_b32 v17, 16, v101
v_and_b32 v18, s65, v97
v_and_b32 v19, s65, v101
v_add_f32 v16, v16, v17
v_add_f32 v18, v18, v19
v_cvt_pk_bf16_f32 v21, v16, v18
v_lshlrev_b32 v16, 16, v98
v_lshlrev_b32 v17, 16, v102
v_and_b32 v18, s65, v98
v_and_b32 v19, s65, v102
v_add_f32 v16, v16, v17
v_add_f32 v18, v18, v19
v_cvt_pk_bf16_f32 v22, v16, v18
v_lshlrev_b32 v16, 16, v99
v_lshlrev_b32 v17, 16, v103
v_and_b32 v18, s65, v99
v_and_b32 v19, s65, v103
v_add_f32 v16, v16, v17
v_add_f32 v18, v18, v19
v_cvt_pk_bf16_f32 v23, v16, v18
s_add_u32 s46, s39, 64
s_mul_i32 s47, s46, 241
s_lshr_b32 s47, s47, 13
s_mul_i32 s48, s47, 34
s_sub_u32 s46, s46, s48
s_mul_i32 s45, s47, 34816
s_add_u32 s45, s45, s64
s_and_b32 s47, s46, 8
s_lshl_b32 s47, s47, 2
v_xor_b32 v15, s47, v12
s_lshl_b32 s46, s46, 10
s_add_u32 s45, s45, s46
buffer_store_dwordx4 v[20:23], v15, s[16:19], s45 offen sc1
s_waitcnt vmcnt(17)
v_lshlrev_b32 v16, 16, v104
v_lshlrev_b32 v17, 16, v108
v_and_b32 v18, s65, v104
v_and_b32 v19, s65, v108
v_add_f32 v16, v16, v17
v_add_f32 v18, v18, v19
v_cvt_pk_bf16_f32 v24, v16, v18
v_lshlrev_b32 v16, 16, v105
v_lshlrev_b32 v17, 16, v109
v_and_b32 v18, s65, v105
v_and_b32 v19, s65, v109
v_add_f32 v16, v16, v17
v_add_f32 v18, v18, v19
v_cvt_pk_bf16_f32 v25, v16, v18
v_lshlrev_b32 v16, 16, v106
v_lshlrev_b32 v17, 16, v110
v_and_b32 v18, s65, v106
v_and_b32 v19, s65, v110
v_add_f32 v16, v16, v17
v_add_f32 v18, v18, v19
v_cvt_pk_bf16_f32 v26, v16, v18
v_lshlrev_b32 v16, 16, v107
v_lshlrev_b32 v17, 16, v111
v_and_b32 v18, s65, v107
v_and_b32 v19, s65, v111
v_add_f32 v16, v16, v17
v_add_f32 v18, v18, v19
v_cvt_pk_bf16_f32 v27, v16, v18
s_add_u32 s46, s39, 72
s_mul_i32 s47, s46, 241
s_lshr_b32 s47, s47, 13
s_mul_i32 s48, s47, 34
s_sub_u32 s46, s46, s48
s_mul_i32 s45, s47, 34816
s_add_u32 s45, s45, s64
s_and_b32 s47, s46, 8
s_lshl_b32 s47, s47, 2
v_xor_b32 v15, s47, v12
s_lshl_b32 s46, s46, 10
s_add_u32 s45, s45, s46
buffer_store_dwordx4 v[24:27], v15, s[16:19], s45 offen sc1
s_barrier
s_waitcnt vmcnt(17)
v_lshlrev_b32 v16, 16, v112
v_lshlrev_b32 v17, 16, v116
v_and_b32 v18, s65, v112
v_and_b32 v19, s65, v116
v_add_f32 v16, v16, v17
v_add_f32 v18, v18, v19
v_cvt_pk_bf16_f32 v20, v16, v18
v_lshlrev_b32 v16, 16, v113
v_lshlrev_b32 v17, 16, v117
v_and_b32 v18, s65, v113
v_and_b32 v19, s65, v117
v_add_f32 v16, v16, v17
v_add_f32 v18, v18, v19
v_cvt_pk_bf16_f32 v21, v16, v18
v_lshlrev_b32 v16, 16, v114
v_lshlrev_b32 v17, 16, v118
v_and_b32 v18, s65, v114
v_and_b32 v19, s65, v118
v_add_f32 v16, v16, v17
v_add_f32 v18, v18, v19
v_cvt_pk_bf16_f32 v22, v16, v18
v_lshlrev_b32 v16, 16, v115
v_lshlrev_b32 v17, 16, v119
v_and_b32 v18, s65, v115
v_and_b32 v19, s65, v119
v_add_f32 v16, v16, v17
v_add_f32 v18, v18, v19
v_cvt_pk_bf16_f32 v23, v16, v18
s_add_u32 s46, s39, 80
s_mul_i32 s47, s46, 241
s_lshr_b32 s47, s47, 13
s_mul_i32 s48, s47, 34
s_sub_u32 s46, s46, s48
s_mul_i32 s45, s47, 34816
s_add_u32 s45, s45, s64
s_and_b32 s47, s46, 8
s_lshl_b32 s47, s47, 2
v_xor_b32 v15, s47, v12
s_lshl_b32 s46, s46, 10
s_add_u32 s45, s45, s46
buffer_store_dwordx4 v[20:23], v15, s[16:19], s45 offen sc1
s_waitcnt vmcnt(17)
v_lshlrev_b32 v16, 16, v120
v_lshlrev_b32 v17, 16, v124
v_and_b32 v18, s65, v120
v_and_b32 v19, s65, v124
v_add_f32 v16, v16, v17
v_add_f32 v18, v18, v19
v_cvt_pk_bf16_f32 v24, v16, v18
v_lshlrev_b32 v16, 16, v121
v_lshlrev_b32 v17, 16, v125
v_and_b32 v18, s65, v121
v_and_b32 v19, s65, v125
v_add_f32 v16, v16, v17
v_add_f32 v18, v18, v19
v_cvt_pk_bf16_f32 v25, v16, v18
v_lshlrev_b32 v16, 16, v122
v_lshlrev_b32 v17, 16, v126
v_and_b32 v18, s65, v122
v_and_b32 v19, s65, v126
v_add_f32 v16, v16, v17
v_add_f32 v18, v18, v19
v_cvt_pk_bf16_f32 v26, v16, v18
v_lshlrev_b32 v16, 16, v123
v_lshlrev_b32 v17, 16, v127
v_and_b32 v18, s65, v123
v_and_b32 v19, s65, v127
v_add_f32 v16, v16, v17
v_add_f32 v18, v18, v19
v_cvt_pk_bf16_f32 v27, v16, v18
s_add_u32 s46, s39, 88
s_mul_i32 s47, s46, 241
s_lshr_b32 s47, s47, 13
s_mul_i32 s48, s47, 34
s_sub_u32 s46, s46, s48
s_mul_i32 s45, s47, 34816
s_add_u32 s45, s45, s64
s_and_b32 s47, s46, 8
s_lshl_b32 s47, s47, 2
v_xor_b32 v15, s47, v12
s_lshl_b32 s46, s46, 10
s_add_u32 s45, s45, s46
buffer_store_dwordx4 v[24:27], v15, s[16:19], s45 offen sc1
s_waitcnt vmcnt(17)
v_lshlrev_b32 v16, 16, v128
v_lshlrev_b32 v17, 16, v132
v_and_b32 v18, s65, v128
v_and_b32 v19, s65, v132
v_add_f32 v16, v16, v17
v_add_f32 v18, v18, v19
v_cvt_pk_bf16_f32 v20, v16, v18
v_lshlrev_b32 v16, 16, v129
v_lshlrev_b32 v17, 16, v133
v_and_b32 v18, s65, v129
v_and_b32 v19, s65, v133
v_add_f32 v16, v16, v17
v_add_f32 v18, v18, v19
v_cvt_pk_bf16_f32 v21, v16, v18
v_lshlrev_b32 v16, 16, v130
v_lshlrev_b32 v17, 16, v134
v_and_b32 v18, s65, v130
v_and_b32 v19, s65, v134
v_add_f32 v16, v16, v17
v_add_f32 v18, v18, v19
v_cvt_pk_bf16_f32 v22, v16, v18
v_lshlrev_b32 v16, 16, v131
v_lshlrev_b32 v17, 16, v135
v_and_b32 v18, s65, v131
v_and_b32 v19, s65, v135
v_add_f32 v16, v16, v17
v_add_f32 v18, v18, v19
v_cvt_pk_bf16_f32 v23, v16, v18
s_add_u32 s46, s39, 96
s_mul_i32 s47, s46, 241
s_lshr_b32 s47, s47, 13
s_mul_i32 s48, s47, 34
s_sub_u32 s46, s46, s48
s_mul_i32 s45, s47, 34816
s_add_u32 s45, s45, s64
s_and_b32 s47, s46, 8
s_lshl_b32 s47, s47, 2
v_xor_b32 v15, s47, v12
s_lshl_b32 s46, s46, 10
s_add_u32 s45, s45, s46
buffer_store_dwordx4 v[20:23], v15, s[16:19], s45 offen sc1
s_barrier
s_waitcnt vmcnt(17)
v_lshlrev_b32 v16, 16, v136
v_lshlrev_b32 v17, 16, v140
v_and_b32 v18, s65, v136
v_and_b32 v19, s65, v140
v_add_f32 v16, v16, v17
v_add_f32 v18, v18, v19
v_cvt_pk_bf16_f32 v24, v16, v18
v_lshlrev_b32 v16, 16, v137
v_lshlrev_b32 v17, 16, v141
v_and_b32 v18, s65, v137
v_and_b32 v19, s65, v141
v_add_f32 v16, v16, v17
v_add_f32 v18, v18, v19
v_cvt_pk_bf16_f32 v25, v16, v18
v_lshlrev_b32 v16, 16, v138
v_lshlrev_b32 v17, 16, v142
v_and_b32 v18, s65, v138
v_and_b32 v19, s65, v142
v_add_f32 v16, v16, v17
v_add_f32 v18, v18, v19
v_cvt_pk_bf16_f32 v26, v16, v18
v_lshlrev_b32 v16, 16, v139
v_lshlrev_b32 v17, 16, v143
v_and_b32 v18, s65, v139
v_and_b32 v19, s65, v143
v_add_f32 v16, v16, v17
v_add_f32 v18, v18, v19
v_cvt_pk_bf16_f32 v27, v16, v18
s_add_u32 s46, s39, 104
s_mul_i32 s47, s46, 241
s_lshr_b32 s47, s47, 13
s_mul_i32 s48, s47, 34
s_sub_u32 s46, s46, s48
s_mul_i32 s45, s47, 34816
s_add_u32 s45, s45, s64
s_and_b32 s47, s46, 8
s_lshl_b32 s47, s47, 2
v_xor_b32 v15, s47, v12
s_lshl_b32 s46, s46, 10
s_add_u32 s45, s45, s46
buffer_store_dwordx4 v[24:27], v15, s[16:19], s45 offen sc1
s_waitcnt vmcnt(17)
v_lshlrev_b32 v16, 16, v144
v_lshlrev_b32 v17, 16, v148
v_and_b32 v18, s65, v144
v_and_b32 v19, s65, v148
v_add_f32 v16, v16, v17
v_add_f32 v18, v18, v19
v_cvt_pk_bf16_f32 v20, v16, v18
v_lshlrev_b32 v16, 16, v145
v_lshlrev_b32 v17, 16, v149
v_and_b32 v18, s65, v145
v_and_b32 v19, s65, v149
v_add_f32 v16, v16, v17
v_add_f32 v18, v18, v19
v_cvt_pk_bf16_f32 v21, v16, v18
v_lshlrev_b32 v16, 16, v146
v_lshlrev_b32 v17, 16, v150
v_and_b32 v18, s65, v146
v_and_b32 v19, s65, v150
v_add_f32 v16, v16, v17
v_add_f32 v18, v18, v19
v_cvt_pk_bf16_f32 v22, v16, v18
v_lshlrev_b32 v16, 16, v147
v_lshlrev_b32 v17, 16, v151
v_and_b32 v18, s65, v147
v_and_b32 v19, s65, v151
v_add_f32 v16, v16, v17
v_add_f32 v18, v18, v19
v_cvt_pk_bf16_f32 v23, v16, v18
s_add_u32 s46, s39, 112
s_mul_i32 s47, s46, 241
s_lshr_b32 s47, s47, 13
s_mul_i32 s48, s47, 34
s_sub_u32 s46, s46, s48
s_mul_i32 s45, s47, 34816
s_add_u32 s45, s45, s64
s_and_b32 s47, s46, 8
s_lshl_b32 s47, s47, 2
v_xor_b32 v15, s47, v12
s_lshl_b32 s46, s46, 10
s_add_u32 s45, s45, s46
buffer_store_dwordx4 v[20:23], v15, s[16:19], s45 offen sc1
s_waitcnt vmcnt(17)
v_lshlrev_b32 v16, 16, v152
v_lshlrev_b32 v17, 16, v156
v_and_b32 v18, s65, v152
v_and_b32 v19, s65, v156
v_add_f32 v16, v16, v17
v_add_f32 v18, v18, v19
v_cvt_pk_bf16_f32 v24, v16, v18
v_lshlrev_b32 v16, 16, v153
v_lshlrev_b32 v17, 16, v157
v_and_b32 v18, s65, v153
v_and_b32 v19, s65, v157
v_add_f32 v16, v16, v17
v_add_f32 v18, v18, v19
v_cvt_pk_bf16_f32 v25, v16, v18
v_lshlrev_b32 v16, 16, v154
v_lshlrev_b32 v17, 16, v158
v_and_b32 v18, s65, v154
v_and_b32 v19, s65, v158
v_add_f32 v16, v16, v17
v_add_f32 v18, v18, v19
v_cvt_pk_bf16_f32 v26, v16, v18
v_lshlrev_b32 v16, 16, v155
v_lshlrev_b32 v17, 16, v159
v_and_b32 v18, s65, v155
v_and_b32 v19, s65, v159
v_add_f32 v16, v16, v17
v_add_f32 v18, v18, v19
v_cvt_pk_bf16_f32 v27, v16, v18
s_add_u32 s46, s39, 120
s_mul_i32 s47, s46, 241
s_lshr_b32 s47, s47, 13
s_mul_i32 s48, s47, 34
s_sub_u32 s46, s46, s48
s_mul_i32 s45, s47, 34816
s_add_u32 s45, s45, s64
s_and_b32 s47, s46, 8
s_lshl_b32 s47, s47, 2
v_xor_b32 v15, s47, v12
s_lshl_b32 s46, s46, 10
s_add_u32 s45, s45, s46
buffer_store_dwordx4 v[24:27], v15, s[16:19], s45 offen sc1
s_barrier
s_waitcnt vmcnt(17)
v_lshlrev_b32 v16, 16, v160
v_lshlrev_b32 v17, 16, v164
v_and_b32 v18, s65, v160
v_and_b32 v19, s65, v164
v_add_f32 v16, v16, v17
v_add_f32 v18, v18, v19
v_cvt_pk_bf16_f32 v20, v16, v18
v_lshlrev_b32 v16, 16, v161
v_lshlrev_b32 v17, 16, v165
v_and_b32 v18, s65, v161
v_and_b32 v19, s65, v165
v_add_f32 v16, v16, v17
v_add_f32 v18, v18, v19
v_cvt_pk_bf16_f32 v21, v16, v18
v_lshlrev_b32 v16, 16, v162
v_lshlrev_b32 v17, 16, v166
v_and_b32 v18, s65, v162
v_and_b32 v19, s65, v166
v_add_f32 v16, v16, v17
v_add_f32 v18, v18, v19
v_cvt_pk_bf16_f32 v22, v16, v18
v_lshlrev_b32 v16, 16, v163
v_lshlrev_b32 v17, 16, v167
v_and_b32 v18, s65, v163
v_and_b32 v19, s65, v167
v_add_f32 v16, v16, v17
v_add_f32 v18, v18, v19
v_cvt_pk_bf16_f32 v23, v16, v18
s_add_u32 s46, s39, 128
s_mul_i32 s47, s46, 241
s_lshr_b32 s47, s47, 13
s_mul_i32 s48, s47, 34
s_sub_u32 s46, s46, s48
s_mul_i32 s45, s47, 34816
s_add_u32 s45, s45, s64
s_and_b32 s47, s46, 8
s_lshl_b32 s47, s47, 2
v_xor_b32 v15, s47, v12
s_lshl_b32 s46, s46, 10
s_add_u32 s45, s45, s46
buffer_store_dwordx4 v[20:23], v15, s[16:19], s45 offen sc1
s_waitcnt vmcnt(37)
v_lshlrev_b32 v16, 16, v176
v_lshlrev_b32 v17, 16, v180
v_and_b32 v18, s65, v176
v_and_b32 v19, s65, v180
v_add_f32 v16, -v16, -v17
v_add_f32 v18, -v18, -v19
v_cvt_pk_bf16_f32 v20, v16, v18
v_lshlrev_b32 v16, 16, v177
v_lshlrev_b32 v17, 16, v181
v_and_b32 v18, s65, v177
v_and_b32 v19, s65, v181
v_add_f32 v16, -v16, -v17
v_add_f32 v18, -v18, -v19
v_cvt_pk_bf16_f32 v21, v16, v18
v_lshlrev_b32 v16, 16, v178
v_lshlrev_b32 v17, 16, v182
v_and_b32 v18, s65, v178
v_and_b32 v19, s65, v182
v_add_f32 v16, -v16, -v17
v_add_f32 v18, -v18, -v19
v_cvt_pk_bf16_f32 v22, v16, v18
v_lshlrev_b32 v16, 16, v179
v_lshlrev_b32 v17, 16, v183
v_and_b32 v18, s65, v179
v_and_b32 v19, s65, v183
v_add_f32 v16, -v16, -v17
v_add_f32 v18, -v18, -v19
v_cvt_pk_bf16_f32 v23, v16, v18
s_add_u32 s45, s67, 32768
buffer_store_dwordx4 v[20:23], v9, s[16:19], s45 offen sc1
s_waitcnt vmcnt(37)
v_lshlrev_b32 v16, 16, v184
v_lshlrev_b32 v17, 16, v188
v_and_b32 v18, s65, v184
v_and_b32 v19, s65, v188
v_add_f32 v16, -v16, -v17
v_add_f32 v18, -v18, -v19
v_cvt_pk_bf16_f32 v24, v16, v18
v_lshlrev_b32 v16, 16, v185
v_lshlrev_b32 v17, 16, v189
v_and_b32 v18, s65, v185
v_and_b32 v19, s65, v189
v_add_f32 v16, -v16, -v17
v_add_f32 v18, -v18, -v19
v_cvt_pk_bf16_f32 v25, v16, v18
v_lshlrev_b32 v16, 16, v186
v_lshlrev_b32 v17, 16, v190
v_and_b32 v18, s65, v186
v_and_b32 v19, s65, v190
v_add_f32 v16, -v16, -v17
v_add_f32 v18, -v18, -v19
v_cvt_pk_bf16_f32 v26, v16, v18
v_lshlrev_b32 v16, 16, v187
v_lshlrev_b32 v17, 16, v191
v_and_b32 v18, s65, v187
v_and_b32 v19, s65, v191
v_add_f32 v16, -v16, -v17
v_add_f32 v18, -v18, -v19
v_cvt_pk_bf16_f32 v27, v16, v18
s_add_u32 s45, s67, 65536
buffer_store_dwordx4 v[24:27], v9, s[16:19], s45 offen sc1
s_barrier
s_waitcnt vmcnt(37)
v_lshlrev_b32 v16, 16, v192
v_lshlrev_b32 v17, 16, v196
v_and_b32 v18, s65, v192
v_and_b32 v19, s65, v196
v_add_f32 v16, -v16, -v17
v_add_f32 v18, -v18, -v19
v_cvt_pk_bf16_f32 v20, v16, v18
v_lshlrev_b32 v16, 16, v193
v_lshlrev_b32 v17, 16, v197
v_and_b32 v18, s65, v193
v_and_b32 v19, s65, v197
v_add_f32 v16, -v16, -v17
v_add_f32 v18, -v18, -v19
v_cvt_pk_bf16_f32 v21, v16, v18
v_lshlrev_b32 v16, 16, v194
v_lshlrev_b32 v17, 16, v198
v_and_b32 v18, s65, v194
v_and_b32 v19, s65, v198
v_add_f32 v16, -v16, -v17
v_add_f32 v18, -v18, -v19
v_cvt_pk_bf16_f32 v22, v16, v18
v_lshlrev_b32 v16, 16, v195
v_lshlrev_b32 v17, 16, v199
v_and_b32 v18, s65, v195
v_and_b32 v19, s65, v199
v_add_f32 v16, -v16, -v17
v_add_f32 v18, -v18, -v19
v_cvt_pk_bf16_f32 v23, v16, v18
s_add_u32 s45, s67, 98304
buffer_store_dwordx4 v[20:23], v9, s[16:19], s45 offen sc1
s_waitcnt vmcnt(20)
v_lshlrev_b32 v16, 16, v168
v_lshlrev_b32 v17, 16, v172
v_and_b32 v18, s65, v168
v_and_b32 v19, s65, v172
v_add_f32 v16, -v16, -v17
v_add_f32 v18, -v18, -v19
v_cvt_pk_bf16_f32 v24, v16, v18
v_lshlrev_b32 v16, 16, v169
v_lshlrev_b32 v17, 16, v173
v_and_b32 v18, s65, v169
v_and_b32 v19, s65, v173
v_add_f32 v16, -v16, -v17
v_add_f32 v18, -v18, -v19
v_cvt_pk_bf16_f32 v25, v16, v18
v_lshlrev_b32 v16, 16, v170
v_lshlrev_b32 v17, 16, v174
v_and_b32 v18, s65, v170
v_and_b32 v19, s65, v174
v_add_f32 v16, -v16, -v17
v_add_f32 v18, -v18, -v19
v_cvt_pk_bf16_f32 v26, v16, v18
v_lshlrev_b32 v16, 16, v171
v_lshlrev_b32 v17, 16, v175
v_and_b32 v18, s65, v171
v_and_b32 v19, s65, v175
v_add_f32 v16, -v16, -v17
v_add_f32 v18, -v18, -v19
v_cvt_pk_bf16_f32 v27, v16, v18
s_add_u32 s45, s67, 0
buffer_store_dwordx4 v[24:27], v9, s[16:19], s45 offen sc1
s_waitcnt vmcnt(20)
v_lshlrev_b32 v16, 16, v32
v_lshlrev_b32 v17, 16, v36
v_and_b32 v18, s65, v32
v_and_b32 v19, s65, v36
v_add_f32 v16, v16, v17
v_add_f32 v18, v18, v19
v_cvt_pk_bf16_f32 v20, v16, v18
v_lshlrev_b32 v16, 16, v33
v_lshlrev_b32 v17, 16, v37
v_and_b32 v18, s65, v33
v_and_b32 v19, s65, v37
v_add_f32 v16, v16, v17
v_add_f32 v18, v18, v19
v_cvt_pk_bf16_f32 v21, v16, v18
v_lshlrev_b32 v16, 16, v34
v_lshlrev_b32 v17, 16, v38
v_and_b32 v18, s65, v34
v_and_b32 v19, s65, v38
v_add_f32 v16, v16, v17
v_add_f32 v18, v18, v19
v_cvt_pk_bf16_f32 v22, v16, v18
v_lshlrev_b32 v16, 16, v35
v_lshlrev_b32 v17, 16, v39
v_and_b32 v18, s65, v35
v_and_b32 v19, s65, v39
v_add_f32 v16, v16, v17
v_add_f32 v18, v18, v19
v_cvt_pk_bf16_f32 v23, v16, v18
s_add_u32 s46, s39, 0
s_mul_i32 s47, s46, 241
s_lshr_b32 s47, s47, 13
s_mul_i32 s48, s47, 34
s_sub_u32 s46, s46, s48
s_mul_i32 s45, s47, 34816
s_add_u32 s45, s45, s64
s_and_b32 s47, s46, 8
s_lshl_b32 s47, s47, 2
v_xor_b32 v15, s47, v12
s_lshl_b32 s46, s46, 10
s_add_u32 s45, s45, s46
buffer_store_dwordx4 v[20:23], v15, s[16:19], s45 offen sc1
s_barrier
s_waitcnt vmcnt(20)
v_lshlrev_b32 v16, 16, v40
v_lshlrev_b32 v17, 16, v44
v_and_b32 v18, s65, v40
v_and_b32 v19, s65, v44
v_add_f32 v16, v16, v17
v_add_f32 v18, v18, v19
v_cvt_pk_bf16_f32 v24, v16, v18
v_lshlrev_b32 v16, 16, v41
v_lshlrev_b32 v17, 16, v45
v_and_b32 v18, s65, v41
v_and_b32 v19, s65, v45
v_add_f32 v16, v16, v17
v_add_f32 v18, v18, v19
v_cvt_pk_bf16_f32 v25, v16, v18
v_lshlrev_b32 v16, 16, v42
v_lshlrev_b32 v17, 16, v46
v_and_b32 v18, s65, v42
v_and_b32 v19, s65, v46
v_add_f32 v16, v16, v17
v_add_f32 v18, v18, v19
v_cvt_pk_bf16_f32 v26, v16, v18
v_lshlrev_b32 v16, 16, v43
v_lshlrev_b32 v17, 16, v47
v_and_b32 v18, s65, v43
v_and_b32 v19, s65, v47
v_add_f32 v16, v16, v17
v_add_f32 v18, v18, v19
v_cvt_pk_bf16_f32 v27, v16, v18
s_add_u32 s46, s39, 8
s_mul_i32 s47, s46, 241
s_lshr_b32 s47, s47, 13
s_mul_i32 s48, s47, 34
s_sub_u32 s46, s46, s48
s_mul_i32 s45, s47, 34816
s_add_u32 s45, s45, s64
s_and_b32 s47, s46, 8
s_lshl_b32 s47, s47, 2
v_xor_b32 v15, s47, v12
s_lshl_b32 s46, s46, 10
s_add_u32 s45, s45, s46
buffer_store_dwordx4 v[24:27], v15, s[16:19], s45 offen sc1
s_waitcnt vmcnt(20)
v_lshlrev_b32 v16, 16, v48
v_lshlrev_b32 v17, 16, v52
v_and_b32 v18, s65, v48
v_and_b32 v19, s65, v52
v_add_f32 v16, v16, v17
v_add_f32 v18, v18, v19
v_cvt_pk_bf16_f32 v20, v16, v18
v_lshlrev_b32 v16, 16, v49
v_lshlrev_b32 v17, 16, v53
v_and_b32 v18, s65, v49
v_and_b32 v19, s65, v53
v_add_f32 v16, v16, v17
v_add_f32 v18, v18, v19
v_cvt_pk_bf16_f32 v21, v16, v18
v_lshlrev_b32 v16, 16, v50
v_lshlrev_b32 v17, 16, v54
v_and_b32 v18, s65, v50
v_and_b32 v19, s65, v54
v_add_f32 v16, v16, v17
v_add_f32 v18, v18, v19
v_cvt_pk_bf16_f32 v22, v16, v18
v_lshlrev_b32 v16, 16, v51
v_lshlrev_b32 v17, 16, v55
v_and_b32 v18, s65, v51
v_and_b32 v19, s65, v55
v_add_f32 v16, v16, v17
v_add_f32 v18, v18, v19
v_cvt_pk_bf16_f32 v23, v16, v18
s_add_u32 s46, s39, 16
s_mul_i32 s47, s46, 241
s_lshr_b32 s47, s47, 13
s_mul_i32 s48, s47, 34
s_sub_u32 s46, s46, s48
s_mul_i32 s45, s47, 34816
s_add_u32 s45, s45, s64
s_and_b32 s47, s46, 8
s_lshl_b32 s47, s47, 2
v_xor_b32 v15, s47, v12
s_lshl_b32 s46, s46, 10
s_add_u32 s45, s45, s46
buffer_store_dwordx4 v[20:23], v15, s[16:19], s45 offen sc1
s_waitcnt vmcnt(20)
v_lshlrev_b32 v16, 16, v56
v_lshlrev_b32 v17, 16, v60
v_and_b32 v18, s65, v56
v_and_b32 v19, s65, v60
v_add_f32 v16, v16, v17
v_add_f32 v18, v18, v19
v_cvt_pk_bf16_f32 v24, v16, v18
v_lshlrev_b32 v16, 16, v57
v_lshlrev_b32 v17, 16, v61
v_and_b32 v18, s65, v57
v_and_b32 v19, s65, v61
v_add_f32 v16, v16, v17
v_add_f32 v18, v18, v19
v_cvt_pk_bf16_f32 v25, v16, v18
v_lshlrev_b32 v16, 16, v58
v_lshlrev_b32 v17, 16, v62
v_and_b32 v18, s65, v58
v_and_b32 v19, s65, v62
v_add_f32 v16, v16, v17
v_add_f32 v18, v18, v19
v_cvt_pk_bf16_f32 v26, v16, v18
v_lshlrev_b32 v16, 16, v59
v_lshlrev_b32 v17, 16, v63
v_and_b32 v18, s65, v59
v_and_b32 v19, s65, v63
v_add_f32 v16, v16, v17
v_add_f32 v18, v18, v19
v_cvt_pk_bf16_f32 v27, v16, v18
s_add_u32 s46, s39, 24
s_mul_i32 s47, s46, 241
s_lshr_b32 s47, s47, 13
s_mul_i32 s48, s47, 34
s_sub_u32 s46, s46, s48
s_mul_i32 s45, s47, 34816
s_add_u32 s45, s45, s64
s_and_b32 s47, s46, 8
s_lshl_b32 s47, s47, 2
v_xor_b32 v15, s47, v12
s_lshl_b32 s46, s46, 10
s_add_u32 s45, s45, s46
buffer_store_dwordx4 v[24:27], v15, s[16:19], s45 offen sc1
s_barrier
s_barrier
s_barrier
s_waitcnt vmcnt(0)
s_barrier
s_cmp_lg_u32 s36, 6
s_cbranch_scc1 L_end2
s_mov_b64 exec, 1
v_mov_b32 v6, 0
v_mov_b32 v7, 1
buffer_atomic_add v7, v6, s[20:23], 0 offen sc1
s_mov_b32 s43, 19
L_tw:
s_barrier
s_add_u32 s43, s43, 1
s_cmp_lt_u32 s43, 25
s_cbranch_scc1 L_tw
buffer_load_dword v7, v6, s[20:23], 0 offen sc1
s_barrier
s_barrier
s_mov_b32 s48, 0
L_tp:
s_waitcnt vmcnt(0)
v_readfirstlane_b32 s47, v7
s_add_u32 s48, s48, 1
s_cmp_ge_u32 s47, 256
s_cbranch_scc1 L_tq
s_cmp_ge_u32 s48, 0x20000
s_cbranch_scc1 L_tq
buffer_load_dword v7, v6, s[20:23], 0 offen sc1
s_branch L_tp
L_tq:
s_barrier
L_end2:
s_endpgm
.p2align 6
L_compute:
s_bfe_u32 s41, s36, 0x10001
s_and_b32 s42, s36, 1
s_lshl_b32 s49, s37, 3
s_or_b32 s49, s49, s39
s_lshl_b32 s49, s49, 1
s_or_b32 s49, s49, s42
s_lshl_b32 s49, s49, 12
s_setprio 1
s_load_dwordx2 s[24:25], s[0:1], 16
s_load_dwordx2 s[28:29], s[0:1], 24
s_load_dwordx2 s[32:33], s[0:1], 32
s_load_dwordx2 s[12:13], s[0:1], 40
s_mov_b32 s14, 8176640
s_mov_b32 s15, 0x00020000
s_mov_b32 s18, 16777216
s_mov_b32 s19, 0x00020000
s_mov_b32 s22, 256
s_mov_b32 s23, 0x00020000
s_mov_b32 s26, 512
s_mov_b32 s27, 0x00020000
s_mov_b32 s30, 512
s_mov_b32 s31, 0x00020000
s_mov_b32 s34, 512
s_mov_b32 s35, 0x00020000
v_and_b32 v239, 15, v238
v_lshrrev_b32 v240, 4, v238
s_lshl_b32 s45, s41, 6
s_add_u32 s45, s45, 65536
s_movk_i32 s46, 2112
v_add_u32 v242, 0, v239
v_bfe_u32 v241, v242, 2, 1
v_lshlrev_b32 v241, 1, v241
v_xor_b32 v241, v241, v240
v_lshlrev_b32 v241, 4, v241
v_mad_u32_u24 v228, v242, s46, v241
v_add_u32 v228, s45, v228
v_add_u32 v242, 1, v239
v_bfe_u32 v241, v242, 2, 1
v_lshlrev_b32 v241, 1, v241
v_xor_b32 v241, v241, v240
v_lshlrev_b32 v241, 4, v241
v_mad_u32_u24 v229, v242, s46, v241
v_add_u32 v229, s45, v229
v_lshrrev_b32 v241, 2, v239
v_lshl_add_u32 v242, v240, 3, v241
v_and_b32 v243, 1, v240
v_xor_b32 v243, s42, v243
v_lshlrev_b32 v243, 5, v243
v_lshl_add_u32 v242, v242, 6, v243
v_and_b32 v243, 3, v238
v_lshl_add_u32 v230, v243, 3, v242
s_lshl_b32 s45, s41, 11
v_add_u32 v230, s45, v230
s_lshl_b32 s45, s39, 6
s_lshl_b32 s46, s42, 5
s_add_u32 s45, s45, s46
v_lshlrev_b32 v241, 3, v240
v_add_u32 v241, s45, v241
s_mul_i32 s46, s37, 7985
s_mul_i32 s47, s38, 500
s_add_u32 s46, s46, s47
s_lshl_b32 s47, s41, 4
s_add_u32 s46, s46, s47
s_lshl_b32 s46, s46, 9
s_add_u32 s46, s46, s45
v_and_b32 v242, 1, v240
v_lshlrev_b32 v242, 9, v242
v_lshrrev_b32 v243, 1, v240
v_lshl_add_u32 v242, v243, 4, v242
v_lshl_add_u32 v245, v239, 14, v242
v_add_u32 v245, s46, v245
v_lshlrev_b32 v242, 4, v238
s_lshl_b32 s46, s36, 12
s_add_u32 s47, s46, 135168
v_add_u32 v246, s47, v242
s_xor_b32 s47, s46, 0x2000
s_add_u32 s47, s47, 135168
v_add_u32 v247, s47, v242
s_lshl_b32 s46, s36, 13
v_add_u32 v253, s46, v242
v_xor_b32 v254, 0x4000, v253
s_mov_b32 s43, 0
s_waitcnt lgkmcnt(0)
s_and_b32 s13, s13, 0xffff
s_and_b32 s17, s17, 0xffff
s_and_b32 s21, s21, 0xffff
s_and_b32 s25, s25, 0xffff
s_and_b32 s29, s29, 0xffff
s_and_b32 s33, s33, 0xffff
buffer_load_dwordx2 v[232:233], v241, s[24:27], 0 offen
buffer_load_dwordx2 v[234:235], v241, s[28:31], 0 offen
buffer_load_dwordx2 v[236:237], v241, s[32:35], 0 offen
s_cmp_eq_u32 s38, 15
s_mov_b32 s54, 0
s_cselect_b32 s46, 3, 8
s_cselect_b32 s47, 0, 2
s_cselect_b32 s48, 998620983, s54
s_cselect_b32 s86, 998803593, s54
s_cmp_lg_u32 s38, 15
s_cselect_b32 s48, 998244352, s48
s_cselect_b32 s86, 998656906, s86
s_cmp_eq_u32 s41, 0
s_cselect_b32 s46, s46, s47
s_cselect_b32 s54, s48, s86
s_cmp_gt_u32 s46, 0
s_cselect_b32 s56, -1, 0x7fff7fff
s_mov_b32 s57, s56
s_cmp_gt_u32 s46, 1
s_cselect_b32 s58, -1, 0x7fff7fff
s_mov_b32 s59, s58
s_cmp_gt_u32 s46, 2
s_cselect_b32 s60, -1, 0x7fff7fff
s_mov_b32 s61, s60
s_cmp_gt_u32 s46, 3
s_cselect_b32 s62, -1, 0x7fff7fff
s_mov_b32 s63, s62
s_cmp_gt_u32 s46, 4
s_cselect_b32 s64, -1, 0x7fff7fff
s_mov_b32 s65, s64
s_cmp_gt_u32 s46, 5
s_cselect_b32 s66, -1, 0x7fff7fff
s_mov_b32 s67, s66
s_cmp_gt_u32 s46, 6
s_cselect_b32 s68, -1, 0x7fff7fff
s_mov_b32 s69, s68
s_cmp_gt_u32 s46, 7
s_cselect_b32 s70, -1, 0x7fff7fff
s_mov_b32 s71, s70
s_cmp_gt_u32 s46, 3
s_cselect_b32 s72, -1, 0x7fff7fff
s_mov_b32 s73, s72
s_and_b32 s47, s60, 0xffff
s_and_b32 s48, s72, 0xffff0000
s_or_b32 s74, s47, s48
s_mov_b32 s75, s74
s_movk_i32 s85, 4096
s_barrier
v_mov_b64 v[0:1], 0
v_mov_b64 v[2:3], 0
v_mov_b64 v[4:5], 0
v_mov_b64 v[6:7], 0
v_mov_b64 v[8:9], 0
v_mov_b64 v[10:11], 0
v_mov_b64 v[12:13], 0
v_mov_b64 v[14:15], 0
v_mov_b64 v[16:17], 0
v_mov_b64 v[18:19], 0
v_mov_b64 v[20:21], 0
v_mov_b64 v[22:23], 0
v_mov_b64 v[24:25], 0
v_mov_b64 v[26:27], 0
v_mov_b64 v[28:29], 0
v_mov_b64 v[30:31], 0
v_mov_b64 v[32:33], 0
v_mov_b64 v[34:35], 0
v_mov_b64 v[36:37], 0
v_mov_b64 v[38:39], 0
v_mov_b64 v[40:41], 0
v_mov_b64 v[42:43], 0
v_mov_b64 v[44:45], 0
v_mov_b64 v[46:47], 0
v_mov_b64 v[48:49], 0
v_mov_b64 v[50:51], 0
v_mov_b64 v[52:53], 0
v_mov_b64 v[54:55], 0
v_mov_b64 v[56:57], 0
v_mov_b64 v[58:59], 0
v_mov_b64 v[60:61], 0
v_mov_b64 v[62:63], 0
v_mov_b64 v[64:65], 0
v_mov_b64 v[66:67], 0
v_mov_b64 v[68:69], 0
v_mov_b64 v[70:71], 0
v_mov_b64 v[72:73], 0
v_mov_b64 v[74:75], 0
v_mov_b64 v[76:77], 0
v_mov_b64 v[78:79], 0
v_mov_b64 v[80:81], 0
v_mov_b64 v[82:83], 0
v_mov_b64 v[84:85], 0
v_mov_b64 v[86:87], 0
v_mov_b64 v[88:89], 0
v_mov_b64 v[90:91], 0
v_mov_b64 v[92:93], 0
v_mov_b64 v[94:95], 0
v_mov_b64 v[96:97], 0
v_mov_b64 v[98:99], 0
v_mov_b64 v[100:101], 0
v_mov_b64 v[102:103], 0
v_mov_b64 v[104:105], 0
v_mov_b64 v[106:107], 0
v_mov_b64 v[108:109], 0
v_mov_b64 v[110:111], 0
v_mov_b64 v[112:113], 0
v_mov_b64 v[114:115], 0
v_mov_b64 v[116:117], 0
v_mov_b64 v[118:119], 0
v_mov_b64 v[120:121], 0
v_mov_b64 v[122:123], 0
v_mov_b64 v[124:125], 0
v_mov_b64 v[126:127], 0
s_barrier
ds_read_b64_tr_b16 v[220:221], v230 offset:0
ds_read_b64_tr_b16 v[222:223], v230 offset:256
ds_read_b128 v[128:131], v228 offset:0
ds_read_b128 v[132:135], v228 offset:128
ds_read_b128 v[136:139], v228 offset:256
ds_read_b128 v[140:143], v228 offset:384
ds_read_b128 v[144:147], v228 offset:512
ds_read_b128 v[148:151], v228 offset:640
ds_read_b128 v[152:155], v228 offset:768
ds_read_b128 v[156:159], v228 offset:896
ds_read_b128 v[160:163], v228 offset:1024
ds_read_b128 v[164:167], v228 offset:1152
ds_read_b128 v[168:171], v228 offset:1280
ds_read_b128 v[172:175], v228 offset:1408
ds_read_b128 v[176:179], v228 offset:1536
ds_read_b128 v[180:183], v228 offset:1664
ds_read_b128 v[184:187], v228 offset:1792
ds_read_b128 v[188:191], v228 offset:1920
.p2align 4
L_loopA:
s_waitcnt lgkmcnt(9)
v_mfma_f32_16x16x32_bf16 v[64:67], v[220:223], v[128:131], v[64:67]
ds_read_b64_tr_b16 v[224:225], v230 offset:4096
ds_read_b64_tr_b16 v[226:227], v230 offset:4352
v_mfma_f32_16x16x32_bf16 v[68:71], v[220:223], v[132:135], v[68:71]
ds_read_b128 v[192:195], v229 offset:0
ds_read_b128 v[196:199], v229 offset:128
v_mfma_f32_16x16x32_bf16 v[72:75], v[220:223], v[136:139], v[72:75]
ds_read_b128 v[200:203], v229 offset:256
v_mfma_f32_16x16x32_bf16 v[76:79], v[220:223], v[140:143], v[76:79]
v_mfma_f32_16x16x32_bf16 v[80:83], v[220:223], v[144:147], v[80:83]
v_mfma_f32_16x16x32_bf16 v[84:87], v[220:223], v[148:151], v[84:87]
v_mfma_f32_16x16x32_bf16 v[88:91], v[220:223], v[152:155], v[88:91]
s_waitcnt lgkmcnt(5)
v_mfma_f32_16x16x32_bf16 v[92:95], v[220:223], v[156:159], v[92:95]
v_mfma_f32_16x16x32_bf16 v[96:99], v[220:223], v[160:163], v[96:99]
v_mfma_f32_16x16x32_bf16 v[100:103], v[220:223], v[164:167], v[100:103]
v_mfma_f32_16x16x32_bf16 v[104:107], v[220:223], v[168:171], v[104:107]
v_mfma_f32_16x16x32_bf16 v[108:111], v[220:223], v[172:175], v[108:111]
v_mfma_f32_16x16x32_bf16 v[112:115], v[220:223], v[176:179], v[112:115]
v_mfma_f32_16x16x32_bf16 v[116:119], v[220:223], v[180:183], v[116:119]
v_mfma_f32_16x16x32_bf16 v[120:123], v[220:223], v[184:187], v[120:123]
v_mfma_f32_16x16x32_bf16 v[124:127], v[220:223], v[188:191], v[124:127]
s_waitcnt lgkmcnt(0)
v_mfma_f32_16x16x32_bf16 v[64:67], v[224:227], v[132:135], v[64:67]
ds_read_b64_tr_b16 v[220:221], v230 offset:8192
ds_read_b64_tr_b16 v[222:223], v230 offset:8448
v_mfma_f32_16x16x32_bf16 v[68:71], v[224:227], v[136:139], v[68:71]
ds_read_b128 v[204:207], v229 offset:384
ds_read_b128 v[208:211], v229 offset:512
v_mfma_f32_16x16x32_bf16 v[72:75], v[224:227], v[140:143], v[72:75]
v_mfma_f32_16x16x32_bf16 v[76:79], v[224:227], v[144:147], v[76:79]
v_mfma_f32_16x16x32_bf16 v[80:83], v[224:227], v[148:151], v[80:83]
v_mfma_f32_16x16x32_bf16 v[84:87], v[224:227], v[152:155], v[84:87]
v_mfma_f32_16x16x32_bf16 v[88:91], v[224:227], v[156:159], v[88:91]
v_mfma_f32_16x16x32_bf16 v[92:95], v[224:227], v[160:163], v[92:95]
v_mfma_f32_16x16x32_bf16 v[96:99], v[224:227], v[164:167], v[96:99]
v_mfma_f32_16x16x32_bf16 v[100:103], v[224:227], v[168:171], v[100:103]
v_mfma_f32_16x16x32_bf16 v[104:107], v[224:227], v[172:175], v[104:107]
v_mfma_f32_16x16x32_bf16 v[108:111], v[224:227], v[176:179], v[108:111]
v_mfma_f32_16x16x32_bf16 v[112:115], v[224:227], v[180:183], v[112:115]
v_mfma_f32_16x16x32_bf16 v[116:119], v[224:227], v[184:187], v[116:119]
v_mfma_f32_16x16x32_bf16 v[120:123], v[224:227], v[188:191], v[120:123]
v_mfma_f32_16x16x32_bf16 v[124:127], v[224:227], v[192:195], v[124:127]
s_waitcnt lgkmcnt(0)
v_mfma_f32_16x16x32_bf16 v[64:67], v[220:223], v[136:139], v[64:67]
ds_read_b64_tr_b16 v[224:225], v230 offset:12288
ds_read_b64_tr_b16 v[226:227], v230 offset:12544
v_mfma_f32_16x16x32_bf16 v[68:71], v[220:223], v[140:143], v[68:71]
ds_read_b128 v[212:215], v229 offset:640
ds_read_b128 v[216:219], v229 offset:768
v_mfma_f32_16x16x32_bf16 v[72:75], v[220:223], v[144:147], v[72:75]
v_mfma_f32_16x16x32_bf16 v[76:79], v[220:223], v[148:151], v[76:79]
v_mfma_f32_16x16x32_bf16 v[80:83], v[220:223], v[152:155], v[80:83]
v_mfma_f32_16x16x32_bf16 v[84:87], v[220:223], v[156:159], v[84:87]
v_mfma_f32_16x16x32_bf16 v[88:91], v[220:223], v[160:163], v[88:91]
v_mfma_f32_16x16x32_bf16 v[92:95], v[220:223], v[164:167], v[92:95]
v_mfma_f32_16x16x32_bf16 v[96:99], v[220:223], v[168:171], v[96:99]
v_mfma_f32_16x16x32_bf16 v[100:103], v[220:223], v[172:175], v[100:103]
v_mfma_f32_16x16x32_bf16 v[104:107], v[220:223], v[176:179], v[104:107]
v_mfma_f32_16x16x32_bf16 v[108:111], v[220:223], v[180:183], v[108:111]
v_mfma_f32_16x16x32_bf16 v[112:115], v[220:223], v[184:187], v[112:115]
v_mfma_f32_16x16x32_bf16 v[116:119], v[220:223], v[188:191], v[116:119]
v_mfma_f32_16x16x32_bf16 v[120:123], v[220:223], v[192:195], v[120:123]
v_mfma_f32_16x16x32_bf16 v[124:127], v[220:223], v[196:199], v[124:127]
s_waitcnt lgkmcnt(0)
s_barrier
v_mfma_f32_16x16x32_bf16 v[64:67], v[224:227], v[140:143], v[64:67]
ds_read_b64_tr_b16 v[220:221], v230 offset:16384
ds_read_b64_tr_b16 v[222:223], v230 offset:16640
v_mfma_f32_16x16x32_bf16 v[68:71], v[224:227], v[144:147], v[68:71]
ds_read_b128 v[128:131], v228 offset:34816
ds_read_b128 v[132:135], v228 offset:34944
v_mfma_f32_16x16x32_bf16 v[72:75], v[224:227], v[148:151], v[72:75]
ds_read_b128 v[136:139], v228 offset:35072
v_mfma_f32_16x16x32_bf16 v[76:79], v[224:227], v[152:155], v[76:79]
v_mfma_f32_16x16x32_bf16 v[80:83], v[224:227], v[156:159], v[80:83]
v_mfma_f32_16x16x32_bf16 v[84:87], v[224:227], v[160:163], v[84:87]
v_mfma_f32_16x16x32_bf16 v[88:91], v[224:227], v[164:167], v[88:91]
v_mfma_f32_16x16x32_bf16 v[92:95], v[224:227], v[168:171], v[92:95]
v_mfma_f32_16x16x32_bf16 v[96:99], v[224:227], v[172:175], v[96:99]
v_mfma_f32_16x16x32_bf16 v[100:103], v[224:227], v[176:179], v[100:103]
v_mfma_f32_16x16x32_bf16 v[104:107], v[224:227], v[180:183], v[104:107]
v_mfma_f32_16x16x32_bf16 v[108:111], v[224:227], v[184:187], v[108:111]
v_mfma_f32_16x16x32_bf16 v[112:115], v[224:227], v[188:191], v[112:115]
v_mfma_f32_16x16x32_bf16 v[116:119], v[224:227], v[192:195], v[116:119]
v_mfma_f32_16x16x32_bf16 v[120:123], v[224:227], v[196:199], v[120:123]
v_mfma_f32_16x16x32_bf16 v[124:127], v[224:227], v[200:203], v[124:127]
s_waitcnt lgkmcnt(0)
v_mfma_f32_16x16x32_bf16 v[64:67], v[220:223], v[144:147], v[64:67]
ds_read_b64_tr_b16 v[224:225], v230 offset:20480
ds_read_b64_tr_b16 v[226:227], v230 offset:20736
v_mfma_f32_16x16x32_bf16 v[68:71], v[220:223], v[148:151], v[68:71]
ds_read_b128 v[140:143], v228 offset:35200
v_mfma_f32_16x16x32_bf16 v[72:75], v[220:223], v[152:155], v[72:75]
v_mfma_f32_16x16x32_bf16 v[76:79], v[220:223], v[156:159], v[76:79]
v_mfma_f32_16x16x32_bf16 v[80:83], v[220:223], v[160:163], v[80:83]
v_mfma_f32_16x16x32_bf16 v[84:87], v[220:223], v[164:167], v[84:87]
v_mfma_f32_16x16x32_bf16 v[88:91], v[220:223], v[168:171], v[88:91]
v_mfma_f32_16x16x32_bf16 v[92:95], v[220:223], v[172:175], v[92:95]
v_mfma_f32_16x16x32_bf16 v[96:99], v[220:223], v[176:179], v[96:99]
v_mfma_f32_16x16x32_bf16 v[100:103], v[220:223], v[180:183], v[100:103]
v_mfma_f32_16x16x32_bf16 v[104:107], v[220:223], v[184:187], v[104:107]
v_mfma_f32_16x16x32_bf16 v[108:111], v[220:223], v[188:191], v[108:111]
v_mfma_f32_16x16x32_bf16 v[112:115], v[220:223], v[192:195], v[112:115]
v_mfma_f32_16x16x32_bf16 v[116:119], v[220:223], v[196:199], v[116:119]
v_mfma_f32_16x16x32_bf16 v[120:123], v[220:223], v[200:203], v[120:123]
v_mfma_f32_16x16x32_bf16 v[124:127], v[220:223], v[204:207], v[124:127]
s_waitcnt lgkmcnt(0)
v_mfma_f32_16x16x32_bf16 v[64:67], v[224:227], v[148:151], v[64:67]
ds_read_b64_tr_b16 v[220:221], v230 offset:24576
ds_read_b64_tr_b16 v[222:223], v230 offset:24832
v_mfma_f32_16x16x32_bf16 v[68:71], v[224:227], v[152:155], v[68:71]
ds_read_b128 v[144:147], v228 offset:35328
v_mfma_f32_16x16x32_bf16 v[72:75], v[224:227], v[156:159], v[72:75]
v_mfma_f32_16x16x32_bf16 v[76:79], v[224:227], v[160:163], v[76:79]
v_mfma_f32_16x16x32_bf16 v[80:83], v[224:227], v[164:167], v[80:83]
v_mfma_f32_16x16x32_bf16 v[84:87], v[224:227], v[168:171], v[84:87]
v_mfma_f32_16x16x32_bf16 v[88:91], v[224:227], v[172:175], v[88:91]
v_mfma_f32_16x16x32_bf16 v[92:95], v[224:227], v[176:179], v[92:95]
v_mfma_f32_16x16x32_bf16 v[96:99], v[224:227], v[180:183], v[96:99]
v_mfma_f32_16x16x32_bf16 v[100:103], v[224:227], v[184:187], v[100:103]
v_mfma_f32_16x16x32_bf16 v[104:107], v[224:227], v[188:191], v[104:107]
v_mfma_f32_16x16x32_bf16 v[108:111], v[224:227], v[192:195], v[108:111]
v_mfma_f32_16x16x32_bf16 v[112:115], v[224:227], v[196:199], v[112:115]
v_mfma_f32_16x16x32_bf16 v[116:119], v[224:227], v[200:203], v[116:119]
v_mfma_f32_16x16x32_bf16 v[120:123], v[224:227], v[204:207], v[120:123]
v_mfma_f32_16x16x32_bf16 v[124:127], v[224:227], v[208:211], v[124:127]
s_waitcnt lgkmcnt(0)
v_mfma_f32_16x16x32_bf16 v[64:67], v[220:223], v[152:155], v[64:67]
ds_read_b64_tr_b16 v[224:225], v230 offset:28672
ds_read_b64_tr_b16 v[226:227], v230 offset:28928
v_mfma_f32_16x16x32_bf16 v[68:71], v[220:223], v[156:159], v[68:71]
ds_read_b128 v[148:151], v228 offset:35456
v_mfma_f32_16x16x32_bf16 v[72:75], v[220:223], v[160:163], v[72:75]
v_mfma_f32_16x16x32_bf16 v[76:79], v[220:223], v[164:167], v[76:79]
v_mfma_f32_16x16x32_bf16 v[80:83], v[220:223], v[168:171], v[80:83]
v_mfma_f32_16x16x32_bf16 v[84:87], v[220:223], v[172:175], v[84:87]
v_mfma_f32_16x16x32_bf16 v[88:91], v[220:223], v[176:179], v[88:91]
v_mfma_f32_16x16x32_bf16 v[92:95], v[220:223], v[180:183], v[92:95]
v_mfma_f32_16x16x32_bf16 v[96:99], v[220:223], v[184:187], v[96:99]
v_mfma_f32_16x16x32_bf16 v[100:103], v[220:223], v[188:191], v[100:103]
v_mfma_f32_16x16x32_bf16 v[104:107], v[220:223], v[192:195], v[104:107]
v_mfma_f32_16x16x32_bf16 v[108:111], v[220:223], v[196:199], v[108:111]
v_mfma_f32_16x16x32_bf16 v[112:115], v[220:223], v[200:203], v[112:115]
v_mfma_f32_16x16x32_bf16 v[116:119], v[220:223], v[204:207], v[116:119]
v_mfma_f32_16x16x32_bf16 v[120:123], v[220:223], v[208:211], v[120:123]
v_mfma_f32_16x16x32_bf16 v[124:127], v[220:223], v[212:215], v[124:127]
s_waitcnt lgkmcnt(0)
s_barrier
v_mfma_f32_16x16x32_bf16 v[64:67], v[224:227], v[156:159], v[64:67]
ds_read_b64_tr_b16 v[220:221], v230 offset:32768
ds_read_b64_tr_b16 v[222:223], v230 offset:33024
v_mfma_f32_16x16x32_bf16 v[68:71], v[224:227], v[160:163], v[68:71]
ds_read_b128 v[152:155], v228 offset:35584
ds_read_b128 v[156:159], v228 offset:35712
v_mfma_f32_16x16x32_bf16 v[72:75], v[224:227], v[164:167], v[72:75]
ds_read_b128 v[160:163], v228 offset:35840
ds_read_b128 v[164:167], v228 offset:35968
v_mfma_f32_16x16x32_bf16 v[76:79], v[224:227], v[168:171], v[76:79]
ds_read_b128 v[168:171], v228 offset:36096
v_mfma_f32_16x16x32_bf16 v[80:83], v[224:227], v[172:175], v[80:83]
ds_read_b128 v[172:175], v228 offset:36224
v_mfma_f32_16x16x32_bf16 v[84:87], v[224:227], v[176:179], v[84:87]
ds_read_b128 v[176:179], v228 offset:36352
v_mfma_f32_16x16x32_bf16 v[88:91], v[224:227], v[180:183], v[88:91]
ds_read_b128 v[180:183], v228 offset:36480
v_mfma_f32_16x16x32_bf16 v[92:95], v[224:227], v[184:187], v[92:95]
ds_read_b128 v[184:187], v228 offset:36608
v_mfma_f32_16x16x32_bf16 v[96:99], v[224:227], v[188:191], v[96:99]
ds_read_b128 v[188:191], v228 offset:36736
v_mfma_f32_16x16x32_bf16 v[100:103], v[224:227], v[192:195], v[100:103]
v_mfma_f32_16x16x32_bf16 v[104:107], v[224:227], v[196:199], v[104:107]
v_mfma_f32_16x16x32_bf16 v[108:111], v[224:227], v[200:203], v[108:111]
v_mfma_f32_16x16x32_bf16 v[112:115], v[224:227], v[204:207], v[112:115]
v_mfma_f32_16x16x32_bf16 v[116:119], v[224:227], v[208:211], v[116:119]
v_mfma_f32_16x16x32_bf16 v[120:123], v[224:227], v[212:215], v[120:123]
v_mfma_f32_16x16x32_bf16 v[124:127], v[224:227], v[216:219], v[124:127]
s_waitcnt lgkmcnt(9)
v_mfma_f32_16x16x32_bf16 v[64:67], v[220:223], v[128:131], v[64:67]
ds_read_b64_tr_b16 v[224:225], v230 offset:36864
ds_read_b64_tr_b16 v[226:227], v230 offset:37120
v_mfma_f32_16x16x32_bf16 v[68:71], v[220:223], v[132:135], v[68:71]
ds_read_b128 v[192:195], v229 offset:34816
ds_read_b128 v[196:199], v229 offset:34944
v_mfma_f32_16x16x32_bf16 v[72:75], v[220:223], v[136:139], v[72:75]
ds_read_b128 v[200:203], v229 offset:35072
v_mfma_f32_16x16x32_bf16 v[76:79], v[220:223], v[140:143], v[76:79]
v_mfma_f32_16x16x32_bf16 v[80:83], v[220:223], v[144:147], v[80:83]
v_mfma_f32_16x16x32_bf16 v[84:87], v[220:223], v[148:151], v[84:87]
v_mfma_f32_16x16x32_bf16 v[88:91], v[220:223], v[152:155], v[88:91]
s_waitcnt lgkmcnt(5)
v_mfma_f32_16x16x32_bf16 v[92:95], v[220:223], v[156:159], v[92:95]
v_mfma_f32_16x16x32_bf16 v[96:99], v[220:223], v[160:163], v[96:99]
v_mfma_f32_16x16x32_bf16 v[100:103], v[220:223], v[164:167], v[100:103]
v_mfma_f32_16x16x32_bf16 v[104:107], v[220:223], v[168:171], v[104:107]
v_mfma_f32_16x16x32_bf16 v[108:111], v[220:223], v[172:175], v[108:111]
v_mfma_f32_16x16x32_bf16 v[112:115], v[220:223], v[176:179], v[112:115]
v_mfma_f32_16x16x32_bf16 v[116:119], v[220:223], v[180:183], v[116:119]
v_mfma_f32_16x16x32_bf16 v[120:123], v[220:223], v[184:187], v[120:123]
v_mfma_f32_16x16x32_bf16 v[124:127], v[220:223], v[188:191], v[124:127]
s_waitcnt lgkmcnt(0)
v_mfma_f32_16x16x32_bf16 v[64:67], v[224:227], v[132:135], v[64:67]
ds_read_b64_tr_b16 v[220:221], v230 offset:40960
ds_read_b64_tr_b16 v[222:223], v230 offset:41216
v_mfma_f32_16x16x32_bf16 v[68:71], v[224:227], v[136:139], v[68:71]
ds_read_b128 v[204:207], v229 offset:35200
ds_read_b128 v[208:211], v229 offset:35328
v_mfma_f32_16x16x32_bf16 v[72:75], v[224:227], v[140:143], v[72:75]
v_mfma_f32_16x16x32_bf16 v[76:79], v[224:227], v[144:147], v[76:79]
v_mfma_f32_16x16x32_bf16 v[80:83], v[224:227], v[148:151], v[80:83]
v_mfma_f32_16x16x32_bf16 v[84:87], v[224:227], v[152:155], v[84:87]
v_mfma_f32_16x16x32_bf16 v[88:91], v[224:227], v[156:159], v[88:91]
v_mfma_f32_16x16x32_bf16 v[92:95], v[224:227], v[160:163], v[92:95]
v_mfma_f32_16x16x32_bf16 v[96:99], v[224:227], v[164:167], v[96:99]
v_mfma_f32_16x16x32_bf16 v[100:103], v[224:227], v[168:171], v[100:103]
v_mfma_f32_16x16x32_bf16 v[104:107], v[224:227], v[172:175], v[104:107]
v_mfma_f32_16x16x32_bf16 v[108:111], v[224:227], v[176:179], v[108:111]
v_mfma_f32_16x16x32_bf16 v[112:115], v[224:227], v[180:183], v[112:115]
v_mfma_f32_16x16x32_bf16 v[116:119], v[224:227], v[184:187], v[116:119]
v_mfma_f32_16x16x32_bf16 v[120:123], v[224:227], v[188:191], v[120:123]
v_mfma_f32_16x16x32_bf16 v[124:127], v[224:227], v[192:195], v[124:127]
s_waitcnt lgkmcnt(0)
v_mfma_f32_16x16x32_bf16 v[64:67], v[220:223], v[136:139], v[64:67]
ds_read_b64_tr_b16 v[224:225], v230 offset:45056
ds_read_b64_tr_b16 v[226:227], v230 offset:45312
v_mfma_f32_16x16x32_bf16 v[68:71], v[220:223], v[140:143], v[68:71]
ds_read_b128 v[212:215], v229 offset:35456
ds_read_b128 v[216:219], v229 offset:35584
v_mfma_f32_16x16x32_bf16 v[72:75], v[220:223], v[144:147], v[72:75]
v_mfma_f32_16x16x32_bf16 v[76:79], v[220:223], v[148:151], v[76:79]
v_mfma_f32_16x16x32_bf16 v[80:83], v[220:223], v[152:155], v[80:83]
v_mfma_f32_16x16x32_bf16 v[84:87], v[220:223], v[156:159], v[84:87]
v_mfma_f32_16x16x32_bf16 v[88:91], v[220:223], v[160:163], v[88:91]
v_mfma_f32_16x16x32_bf16 v[92:95], v[220:223], v[164:167], v[92:95]
v_mfma_f32_16x16x32_bf16 v[96:99], v[220:223], v[168:171], v[96:99]
v_mfma_f32_16x16x32_bf16 v[100:103], v[220:223], v[172:175], v[100:103]
v_mfma_f32_16x16x32_bf16 v[104:107], v[220:223], v[176:179], v[104:107]
v_mfma_f32_16x16x32_bf16 v[108:111], v[220:223], v[180:183], v[108:111]
v_mfma_f32_16x16x32_bf16 v[112:115], v[220:223], v[184:187], v[112:115]
v_mfma_f32_16x16x32_bf16 v[116:119], v[220:223], v[188:191], v[116:119]
v_mfma_f32_16x16x32_bf16 v[120:123], v[220:223], v[192:195], v[120:123]
v_mfma_f32_16x16x32_bf16 v[124:127], v[220:223], v[196:199], v[124:127]
s_waitcnt lgkmcnt(0)
s_barrier
v_mfma_f32_16x16x32_bf16 v[64:67], v[224:227], v[140:143], v[64:67]
ds_read_b64_tr_b16 v[220:221], v230 offset:49152
ds_read_b64_tr_b16 v[222:223], v230 offset:49408
v_mfma_f32_16x16x32_bf16 v[68:71], v[224:227], v[144:147], v[68:71]
ds_read_b128 v[128:131], v228 offset:0
ds_read_b128 v[132:135], v228 offset:128
v_mfma_f32_16x16x32_bf16 v[72:75], v[224:227], v[148:151], v[72:75]
ds_read_b128 v[136:139], v228 offset:256
v_mfma_f32_16x16x32_bf16 v[76:79], v[224:227], v[152:155], v[76:79]
v_mfma_f32_16x16x32_bf16 v[80:83], v[224:227], v[156:159], v[80:83]
v_mfma_f32_16x16x32_bf16 v[84:87], v[224:227], v[160:163], v[84:87]
v_mfma_f32_16x16x32_bf16 v[88:91], v[224:227], v[164:167], v[88:91]
v_mfma_f32_16x16x32_bf16 v[92:95], v[224:227], v[168:171], v[92:95]
v_mfma_f32_16x16x32_bf16 v[96:99], v[224:227], v[172:175], v[96:99]
v_mfma_f32_16x16x32_bf16 v[100:103], v[224:227], v[176:179], v[100:103]
v_mfma_f32_16x16x32_bf16 v[104:107], v[224:227], v[180:183], v[104:107]
v_mfma_f32_16x16x32_bf16 v[108:111], v[224:227], v[184:187], v[108:111]
v_mfma_f32_16x16x32_bf16 v[112:115], v[224:227], v[188:191], v[112:115]
v_mfma_f32_16x16x32_bf16 v[116:119], v[224:227], v[192:195], v[116:119]
v_mfma_f32_16x16x32_bf16 v[120:123], v[224:227], v[196:199], v[120:123]
v_mfma_f32_16x16x32_bf16 v[124:127], v[224:227], v[200:203], v[124:127]
s_waitcnt lgkmcnt(0)
v_mfma_f32_16x16x32_bf16 v[64:67], v[220:223], v[144:147], v[64:67]
ds_read_b64_tr_b16 v[224:225], v230 offset:53248
ds_read_b64_tr_b16 v[226:227], v230 offset:53504
v_mfma_f32_16x16x32_bf16 v[68:71], v[220:223], v[148:151], v[68:71]
ds_read_b128 v[140:143], v228 offset:384
v_mfma_f32_16x16x32_bf16 v[72:75], v[220:223], v[152:155], v[72:75]
v_mfma_f32_16x16x32_bf16 v[76:79], v[220:223], v[156:159], v[76:79]
v_mfma_f32_16x16x32_bf16 v[80:83], v[220:223], v[160:163], v[80:83]
v_mfma_f32_16x16x32_bf16 v[84:87], v[220:223], v[164:167], v[84:87]
v_mfma_f32_16x16x32_bf16 v[88:91], v[220:223], v[168:171], v[88:91]
v_mfma_f32_16x16x32_bf16 v[92:95], v[220:223], v[172:175], v[92:95]
v_mfma_f32_16x16x32_bf16 v[96:99], v[220:223], v[176:179], v[96:99]
v_mfma_f32_16x16x32_bf16 v[100:103], v[220:223], v[180:183], v[100:103]
v_mfma_f32_16x16x32_bf16 v[104:107], v[220:223], v[184:187], v[104:107]
v_mfma_f32_16x16x32_bf16 v[108:111], v[220:223], v[188:191], v[108:111]
v_mfma_f32_16x16x32_bf16 v[112:115], v[220:223], v[192:195], v[112:115]
v_mfma_f32_16x16x32_bf16 v[116:119], v[220:223], v[196:199], v[116:119]
v_mfma_f32_16x16x32_bf16 v[120:123], v[220:223], v[200:203], v[120:123]
v_mfma_f32_16x16x32_bf16 v[124:127], v[220:223], v[204:207], v[124:127]
s_waitcnt lgkmcnt(0)
v_mfma_f32_16x16x32_bf16 v[64:67], v[224:227], v[148:151], v[64:67]
ds_read_b64_tr_b16 v[248:249], v230 offset:57344
ds_read_b64_tr_b16 v[250:251], v230 offset:57600
v_mfma_f32_16x16x32_bf16 v[68:71], v[224:227], v[152:155], v[68:71]
ds_read_b128 v[144:147], v228 offset:512
v_mfma_f32_16x16x32_bf16 v[72:75], v[224:227], v[156:159], v[72:75]
v_mfma_f32_16x16x32_bf16 v[76:79], v[224:227], v[160:163], v[76:79]
v_mfma_f32_16x16x32_bf16 v[80:83], v[224:227], v[164:167], v[80:83]
v_mfma_f32_16x16x32_bf16 v[84:87], v[224:227], v[168:171], v[84:87]
v_mfma_f32_16x16x32_bf16 v[88:91], v[224:227], v[172:175], v[88:91]
v_mfma_f32_16x16x32_bf16 v[92:95], v[224:227], v[176:179], v[92:95]
v_mfma_f32_16x16x32_bf16 v[96:99], v[224:227], v[180:183], v[96:99]
v_mfma_f32_16x16x32_bf16 v[100:103], v[224:227], v[184:187], v[100:103]
v_mfma_f32_16x16x32_bf16 v[104:107], v[224:227], v[188:191], v[104:107]
v_mfma_f32_16x16x32_bf16 v[108:111], v[224:227], v[192:195], v[108:111]
v_mfma_f32_16x16x32_bf16 v[112:115], v[224:227], v[196:199], v[112:115]
v_mfma_f32_16x16x32_bf16 v[116:119], v[224:227], v[200:203], v[116:119]
v_mfma_f32_16x16x32_bf16 v[120:123], v[224:227], v[204:207], v[120:123]
v_mfma_f32_16x16x32_bf16 v[124:127], v[224:227], v[208:211], v[124:127]
s_waitcnt lgkmcnt(0)
v_mfma_f32_16x16x32_bf16 v[64:67], v[248:251], v[152:155], v[64:67]
ds_read_b64_tr_b16 v[224:225], v230 offset:61440
ds_read_b64_tr_b16 v[226:227], v230 offset:61696
v_mfma_f32_16x16x32_bf16 v[68:71], v[248:251], v[156:159], v[68:71]
ds_read_b128 v[148:151], v228 offset:640
v_mfma_f32_16x16x32_bf16 v[72:75], v[248:251], v[160:163], v[72:75]
v_mfma_f32_16x16x32_bf16 v[76:79], v[248:251], v[164:167], v[76:79]
v_mfma_f32_16x16x32_bf16 v[80:83], v[248:251], v[168:171], v[80:83]
v_mfma_f32_16x16x32_bf16 v[84:87], v[248:251], v[172:175], v[84:87]
v_mfma_f32_16x16x32_bf16 v[88:91], v[248:251], v[176:179], v[88:91]
v_mfma_f32_16x16x32_bf16 v[92:95], v[248:251], v[180:183], v[92:95]
v_mfma_f32_16x16x32_bf16 v[96:99], v[248:251], v[184:187], v[96:99]
v_mfma_f32_16x16x32_bf16 v[100:103], v[248:251], v[188:191], v[100:103]
v_mfma_f32_16x16x32_bf16 v[104:107], v[248:251], v[192:195], v[104:107]
v_mfma_f32_16x16x32_bf16 v[108:111], v[248:251], v[196:199], v[108:111]
v_mfma_f32_16x16x32_bf16 v[112:115], v[248:251], v[200:203], v[112:115]
v_mfma_f32_16x16x32_bf16 v[116:119], v[248:251], v[204:207], v[116:119]
v_mfma_f32_16x16x32_bf16 v[120:123], v[248:251], v[208:211], v[120:123]
v_mfma_f32_16x16x32_bf16 v[124:127], v[248:251], v[212:215], v[124:127]
s_waitcnt lgkmcnt(0)
s_barrier
v_mfma_f32_16x16x32_bf16 v[64:67], v[224:227], v[156:159], v[64:67]
ds_read_b64_tr_b16 v[220:221], v230 offset:0
ds_read_b64_tr_b16 v[222:223], v230 offset:256
v_mfma_f32_16x16x32_bf16 v[68:71], v[224:227], v[160:163], v[68:71]
ds_read_b128 v[152:155], v228 offset:768
ds_read_b128 v[156:159], v228 offset:896
v_mfma_f32_16x16x32_bf16 v[72:75], v[224:227], v[164:167], v[72:75]
ds_read_b128 v[160:163], v228 offset:1024
ds_read_b128 v[164:167], v228 offset:1152
v_mfma_f32_16x16x32_bf16 v[76:79], v[224:227], v[168:171], v[76:79]
ds_read_b128 v[168:171], v228 offset:1280
v_mfma_f32_16x16x32_bf16 v[80:83], v[224:227], v[172:175], v[80:83]
ds_read_b128 v[172:175], v228 offset:1408
v_mfma_f32_16x16x32_bf16 v[84:87], v[224:227], v[176:179], v[84:87]
ds_read_b128 v[176:179], v228 offset:1536
v_mfma_f32_16x16x32_bf16 v[88:91], v[224:227], v[180:183], v[88:91]
ds_read_b128 v[180:183], v228 offset:1664
v_mfma_f32_16x16x32_bf16 v[92:95], v[224:227], v[184:187], v[92:95]
ds_read_b128 v[184:187], v228 offset:1792
v_mfma_f32_16x16x32_bf16 v[96:99], v[224:227], v[188:191], v[96:99]
ds_read_b128 v[188:191], v228 offset:1920
v_mfma_f32_16x16x32_bf16 v[100:103], v[224:227], v[192:195], v[100:103]
v_mfma_f32_16x16x32_bf16 v[104:107], v[224:227], v[196:199], v[104:107]
v_mfma_f32_16x16x32_bf16 v[108:111], v[224:227], v[200:203], v[108:111]
v_mfma_f32_16x16x32_bf16 v[112:115], v[224:227], v[204:207], v[112:115]
v_mfma_f32_16x16x32_bf16 v[116:119], v[224:227], v[208:211], v[116:119]
s_add_u32 s43, s43, 1
v_mfma_f32_16x16x32_bf16 v[120:123], v[224:227], v[212:215], v[120:123]
s_cmp_lt_u32 s43, 4
v_mfma_f32_16x16x32_bf16 v[124:127], v[224:227], v[216:219], v[124:127]
s_cbranch_scc1 L_loopA
.p2align 4
L_loopB:
s_waitcnt lgkmcnt(9)
v_mfma_f32_16x16x32_bf16 v[0:3], v[220:223], v[128:131], v[0:3]
ds_read_b64_tr_b16 v[224:225], v230 offset:4096
ds_read_b64_tr_b16 v[226:227], v230 offset:4352
v_mfma_f32_16x16x32_bf16 v[4:7], v[220:223], v[132:135], v[4:7]
ds_read_b128 v[192:195], v229 offset:0
ds_read_b128 v[196:199], v229 offset:128
v_mfma_f32_16x16x32_bf16 v[8:11], v[220:223], v[136:139], v[8:11]
ds_read_b128 v[200:203], v229 offset:256
v_mfma_f32_16x16x32_bf16 v[12:15], v[220:223], v[140:143], v[12:15]
v_mfma_f32_16x16x32_bf16 v[16:19], v[220:223], v[144:147], v[16:19]
v_mfma_f32_16x16x32_bf16 v[20:23], v[220:223], v[148:151], v[20:23]
v_mfma_f32_16x16x32_bf16 v[24:27], v[220:223], v[152:155], v[24:27]
s_waitcnt lgkmcnt(5)
v_mfma_f32_16x16x32_bf16 v[28:31], v[220:223], v[156:159], v[28:31]
v_mfma_f32_16x16x32_bf16 v[32:35], v[220:223], v[160:163], v[32:35]
v_mfma_f32_16x16x32_bf16 v[36:39], v[220:223], v[164:167], v[36:39]
v_mfma_f32_16x16x32_bf16 v[40:43], v[220:223], v[168:171], v[40:43]
v_mfma_f32_16x16x32_bf16 v[44:47], v[220:223], v[172:175], v[44:47]
v_mfma_f32_16x16x32_bf16 v[48:51], v[220:223], v[176:179], v[48:51]
v_mfma_f32_16x16x32_bf16 v[52:55], v[220:223], v[180:183], v[52:55]
v_mfma_f32_16x16x32_bf16 v[56:59], v[220:223], v[184:187], v[56:59]
v_mfma_f32_16x16x32_bf16 v[60:63], v[220:223], v[188:191], v[60:63]
s_waitcnt lgkmcnt(0)
v_mfma_f32_16x16x32_bf16 v[0:3], v[224:227], v[132:135], v[0:3]
ds_read_b64_tr_b16 v[220:221], v230 offset:8192
ds_read_b64_tr_b16 v[222:223], v230 offset:8448
v_mfma_f32_16x16x32_bf16 v[4:7], v[224:227], v[136:139], v[4:7]
ds_read_b128 v[204:207], v229 offset:384
ds_read_b128 v[208:211], v229 offset:512
v_mfma_f32_16x16x32_bf16 v[8:11], v[224:227], v[140:143], v[8:11]
v_mfma_f32_16x16x32_bf16 v[12:15], v[224:227], v[144:147], v[12:15]
v_mfma_f32_16x16x32_bf16 v[16:19], v[224:227], v[148:151], v[16:19]
v_mfma_f32_16x16x32_bf16 v[20:23], v[224:227], v[152:155], v[20:23]
v_mfma_f32_16x16x32_bf16 v[24:27], v[224:227], v[156:159], v[24:27]
v_mfma_f32_16x16x32_bf16 v[28:31], v[224:227], v[160:163], v[28:31]
v_mfma_f32_16x16x32_bf16 v[32:35], v[224:227], v[164:167], v[32:35]
v_mfma_f32_16x16x32_bf16 v[36:39], v[224:227], v[168:171], v[36:39]
v_mfma_f32_16x16x32_bf16 v[40:43], v[224:227], v[172:175], v[40:43]
v_mfma_f32_16x16x32_bf16 v[44:47], v[224:227], v[176:179], v[44:47]
v_mfma_f32_16x16x32_bf16 v[48:51], v[224:227], v[180:183], v[48:51]
v_mfma_f32_16x16x32_bf16 v[52:55], v[224:227], v[184:187], v[52:55]
v_mfma_f32_16x16x32_bf16 v[56:59], v[224:227], v[188:191], v[56:59]
v_mfma_f32_16x16x32_bf16 v[60:63], v[224:227], v[192:195], v[60:63]
s_waitcnt lgkmcnt(0)
v_mfma_f32_16x16x32_bf16 v[0:3], v[220:223], v[136:139], v[0:3]
ds_read_b64_tr_b16 v[224:225], v230 offset:12288
ds_read_b64_tr_b16 v[226:227], v230 offset:12544
v_mfma_f32_16x16x32_bf16 v[4:7], v[220:223], v[140:143], v[4:7]
ds_read_b128 v[212:215], v229 offset:640
ds_read_b128 v[216:219], v229 offset:768
v_mfma_f32_16x16x32_bf16 v[8:11], v[220:223], v[144:147], v[8:11]
v_mfma_f32_16x16x32_bf16 v[12:15], v[220:223], v[148:151], v[12:15]
v_mfma_f32_16x16x32_bf16 v[16:19], v[220:223], v[152:155], v[16:19]
v_mfma_f32_16x16x32_bf16 v[20:23], v[220:223], v[156:159], v[20:23]
v_mfma_f32_16x16x32_bf16 v[24:27], v[220:223], v[160:163], v[24:27]
v_mfma_f32_16x16x32_bf16 v[28:31], v[220:223], v[164:167], v[28:31]
v_mfma_f32_16x16x32_bf16 v[32:35], v[220:223], v[168:171], v[32:35]
v_mfma_f32_16x16x32_bf16 v[36:39], v[220:223], v[172:175], v[36:39]
v_mfma_f32_16x16x32_bf16 v[40:43], v[220:223], v[176:179], v[40:43]
v_mfma_f32_16x16x32_bf16 v[44:47], v[220:223], v[180:183], v[44:47]
v_mfma_f32_16x16x32_bf16 v[48:51], v[220:223], v[184:187], v[48:51]
v_mfma_f32_16x16x32_bf16 v[52:55], v[220:223], v[188:191], v[52:55]
v_mfma_f32_16x16x32_bf16 v[56:59], v[220:223], v[192:195], v[56:59]
v_mfma_f32_16x16x32_bf16 v[60:63], v[220:223], v[196:199], v[60:63]
s_waitcnt lgkmcnt(0)
s_barrier
v_mfma_f32_16x16x32_bf16 v[0:3], v[224:227], v[140:143], v[0:3]
ds_read_b64_tr_b16 v[220:221], v230 offset:16384
ds_read_b64_tr_b16 v[222:223], v230 offset:16640
v_mfma_f32_16x16x32_bf16 v[4:7], v[224:227], v[144:147], v[4:7]
ds_read_b128 v[128:131], v228 offset:34816
ds_read_b128 v[132:135], v228 offset:34944
v_mfma_f32_16x16x32_bf16 v[8:11], v[224:227], v[148:151], v[8:11]
ds_read_b128 v[136:139], v228 offset:35072
v_mfma_f32_16x16x32_bf16 v[12:15], v[224:227], v[152:155], v[12:15]
v_mfma_f32_16x16x32_bf16 v[16:19], v[224:227], v[156:159], v[16:19]
v_mfma_f32_16x16x32_bf16 v[20:23], v[224:227], v[160:163], v[20:23]
v_mfma_f32_16x16x32_bf16 v[24:27], v[224:227], v[164:167], v[24:27]
v_mfma_f32_16x16x32_bf16 v[28:31], v[224:227], v[168:171], v[28:31]
v_mfma_f32_16x16x32_bf16 v[32:35], v[224:227], v[172:175], v[32:35]
v_mfma_f32_16x16x32_bf16 v[36:39], v[224:227], v[176:179], v[36:39]
v_mfma_f32_16x16x32_bf16 v[40:43], v[224:227], v[180:183], v[40:43]
v_mfma_f32_16x16x32_bf16 v[44:47], v[224:227], v[184:187], v[44:47]
v_mfma_f32_16x16x32_bf16 v[48:51], v[224:227], v[188:191], v[48:51]
v_mfma_f32_16x16x32_bf16 v[52:55], v[224:227], v[192:195], v[52:55]
v_mfma_f32_16x16x32_bf16 v[56:59], v[224:227], v[196:199], v[56:59]
v_mfma_f32_16x16x32_bf16 v[60:63], v[224:227], v[200:203], v[60:63]
s_waitcnt lgkmcnt(0)
v_mfma_f32_16x16x32_bf16 v[0:3], v[220:223], v[144:147], v[0:3]
ds_read_b64_tr_b16 v[224:225], v230 offset:20480
ds_read_b64_tr_b16 v[226:227], v230 offset:20736
v_mfma_f32_16x16x32_bf16 v[4:7], v[220:223], v[148:151], v[4:7]
ds_read_b128 v[140:143], v228 offset:35200
v_mfma_f32_16x16x32_bf16 v[8:11], v[220:223], v[152:155], v[8:11]
v_mfma_f32_16x16x32_bf16 v[12:15], v[220:223], v[156:159], v[12:15]
v_mfma_f32_16x16x32_bf16 v[16:19], v[220:223], v[160:163], v[16:19]
v_mfma_f32_16x16x32_bf16 v[20:23], v[220:223], v[164:167], v[20:23]
v_mfma_f32_16x16x32_bf16 v[24:27], v[220:223], v[168:171], v[24:27]
v_mfma_f32_16x16x32_bf16 v[28:31], v[220:223], v[172:175], v[28:31]
v_mfma_f32_16x16x32_bf16 v[32:35], v[220:223], v[176:179], v[32:35]
v_mfma_f32_16x16x32_bf16 v[36:39], v[220:223], v[180:183], v[36:39]
v_mfma_f32_16x16x32_bf16 v[40:43], v[220:223], v[184:187], v[40:43]
v_mfma_f32_16x16x32_bf16 v[44:47], v[220:223], v[188:191], v[44:47]
v_mfma_f32_16x16x32_bf16 v[48:51], v[220:223], v[192:195], v[48:51]
v_mfma_f32_16x16x32_bf16 v[52:55], v[220:223], v[196:199], v[52:55]
v_mfma_f32_16x16x32_bf16 v[56:59], v[220:223], v[200:203], v[56:59]
v_mfma_f32_16x16x32_bf16 v[60:63], v[220:223], v[204:207], v[60:63]
s_waitcnt lgkmcnt(0)
v_mfma_f32_16x16x32_bf16 v[0:3], v[224:227], v[148:151], v[0:3]
ds_read_b64_tr_b16 v[220:221], v230 offset:24576
ds_read_b64_tr_b16 v[222:223], v230 offset:24832
v_mfma_f32_16x16x32_bf16 v[4:7], v[224:227], v[152:155], v[4:7]
ds_read_b128 v[144:147], v228 offset:35328
v_mfma_f32_16x16x32_bf16 v[8:11], v[224:227], v[156:159], v[8:11]
v_mfma_f32_16x16x32_bf16 v[12:15], v[224:227], v[160:163], v[12:15]
v_mfma_f32_16x16x32_bf16 v[16:19], v[224:227], v[164:167], v[16:19]
v_mfma_f32_16x16x32_bf16 v[20:23], v[224:227], v[168:171], v[20:23]
v_mfma_f32_16x16x32_bf16 v[24:27], v[224:227], v[172:175], v[24:27]
v_mfma_f32_16x16x32_bf16 v[28:31], v[224:227], v[176:179], v[28:31]
v_mfma_f32_16x16x32_bf16 v[32:35], v[224:227], v[180:183], v[32:35]
v_mfma_f32_16x16x32_bf16 v[36:39], v[224:227], v[184:187], v[36:39]
v_mfma_f32_16x16x32_bf16 v[40:43], v[224:227], v[188:191], v[40:43]
v_mfma_f32_16x16x32_bf16 v[44:47], v[224:227], v[192:195], v[44:47]
v_mfma_f32_16x16x32_bf16 v[48:51], v[224:227], v[196:199], v[48:51]
v_mfma_f32_16x16x32_bf16 v[52:55], v[224:227], v[200:203], v[52:55]
v_mfma_f32_16x16x32_bf16 v[56:59], v[224:227], v[204:207], v[56:59]
v_mfma_f32_16x16x32_bf16 v[60:63], v[224:227], v[208:211], v[60:63]
s_waitcnt lgkmcnt(0)
v_mfma_f32_16x16x32_bf16 v[0:3], v[220:223], v[152:155], v[0:3]
ds_read_b64_tr_b16 v[224:225], v230 offset:28672
ds_read_b64_tr_b16 v[226:227], v230 offset:28928
v_mfma_f32_16x16x32_bf16 v[4:7], v[220:223], v[156:159], v[4:7]
ds_read_b128 v[148:151], v228 offset:35456
v_mfma_f32_16x16x32_bf16 v[8:11], v[220:223], v[160:163], v[8:11]
v_mfma_f32_16x16x32_bf16 v[12:15], v[220:223], v[164:167], v[12:15]
v_mfma_f32_16x16x32_bf16 v[16:19], v[220:223], v[168:171], v[16:19]
v_mfma_f32_16x16x32_bf16 v[20:23], v[220:223], v[172:175], v[20:23]
v_mfma_f32_16x16x32_bf16 v[24:27], v[220:223], v[176:179], v[24:27]
v_mfma_f32_16x16x32_bf16 v[28:31], v[220:223], v[180:183], v[28:31]
v_mfma_f32_16x16x32_bf16 v[32:35], v[220:223], v[184:187], v[32:35]
v_mfma_f32_16x16x32_bf16 v[36:39], v[220:223], v[188:191], v[36:39]
v_mfma_f32_16x16x32_bf16 v[40:43], v[220:223], v[192:195], v[40:43]
v_mfma_f32_16x16x32_bf16 v[44:47], v[220:223], v[196:199], v[44:47]
v_mfma_f32_16x16x32_bf16 v[48:51], v[220:223], v[200:203], v[48:51]
v_mfma_f32_16x16x32_bf16 v[52:55], v[220:223], v[204:207], v[52:55]
v_mfma_f32_16x16x32_bf16 v[56:59], v[220:223], v[208:211], v[56:59]
v_mfma_f32_16x16x32_bf16 v[60:63], v[220:223], v[212:215], v[60:63]
s_waitcnt lgkmcnt(0)
s_barrier
v_mfma_f32_16x16x32_bf16 v[0:3], v[224:227], v[156:159], v[0:3]
ds_read_b64_tr_b16 v[220:221], v230 offset:32768
ds_read_b64_tr_b16 v[222:223], v230 offset:33024
v_mfma_f32_16x16x32_bf16 v[4:7], v[224:227], v[160:163], v[4:7]
ds_read_b128 v[152:155], v228 offset:35584
ds_read_b128 v[156:159], v228 offset:35712
v_mfma_f32_16x16x32_bf16 v[8:11], v[224:227], v[164:167], v[8:11]
ds_read_b128 v[160:163], v228 offset:35840
ds_read_b128 v[164:167], v228 offset:35968
v_mfma_f32_16x16x32_bf16 v[12:15], v[224:227], v[168:171], v[12:15]
ds_read_b128 v[168:171], v228 offset:36096
v_mfma_f32_16x16x32_bf16 v[16:19], v[224:227], v[172:175], v[16:19]
ds_read_b128 v[172:175], v228 offset:36224
v_mfma_f32_16x16x32_bf16 v[20:23], v[224:227], v[176:179], v[20:23]
ds_read_b128 v[176:179], v228 offset:36352
v_mfma_f32_16x16x32_bf16 v[24:27], v[224:227], v[180:183], v[24:27]
ds_read_b128 v[180:183], v228 offset:36480
v_mfma_f32_16x16x32_bf16 v[28:31], v[224:227], v[184:187], v[28:31]
ds_read_b128 v[184:187], v228 offset:36608
v_mfma_f32_16x16x32_bf16 v[32:35], v[224:227], v[188:191], v[32:35]
ds_read_b128 v[188:191], v228 offset:36736
v_mfma_f32_16x16x32_bf16 v[36:39], v[224:227], v[192:195], v[36:39]
v_mfma_f32_16x16x32_bf16 v[40:43], v[224:227], v[196:199], v[40:43]
v_mfma_f32_16x16x32_bf16 v[44:47], v[224:227], v[200:203], v[44:47]
v_mfma_f32_16x16x32_bf16 v[48:51], v[224:227], v[204:207], v[48:51]
v_mfma_f32_16x16x32_bf16 v[52:55], v[224:227], v[208:211], v[52:55]
v_mfma_f32_16x16x32_bf16 v[56:59], v[224:227], v[212:215], v[56:59]
v_mfma_f32_16x16x32_bf16 v[60:63], v[224:227], v[216:219], v[60:63]
s_waitcnt lgkmcnt(9)
v_mfma_f32_16x16x32_bf16 v[0:3], v[220:223], v[128:131], v[0:3]
ds_read_b64_tr_b16 v[224:225], v230 offset:36864
ds_read_b64_tr_b16 v[226:227], v230 offset:37120
v_mfma_f32_16x16x32_bf16 v[4:7], v[220:223], v[132:135], v[4:7]
ds_read_b128 v[192:195], v229 offset:34816
ds_read_b128 v[196:199], v229 offset:34944
v_mfma_f32_16x16x32_bf16 v[8:11], v[220:223], v[136:139], v[8:11]
ds_read_b128 v[200:203], v229 offset:35072
v_mfma_f32_16x16x32_bf16 v[12:15], v[220:223], v[140:143], v[12:15]
v_mfma_f32_16x16x32_bf16 v[16:19], v[220:223], v[144:147], v[16:19]
v_mfma_f32_16x16x32_bf16 v[20:23], v[220:223], v[148:151], v[20:23]
v_mfma_f32_16x16x32_bf16 v[24:27], v[220:223], v[152:155], v[24:27]
s_waitcnt lgkmcnt(5)
v_mfma_f32_16x16x32_bf16 v[28:31], v[220:223], v[156:159], v[28:31]
v_mfma_f32_16x16x32_bf16 v[32:35], v[220:223], v[160:163], v[32:35]
v_mfma_f32_16x16x32_bf16 v[36:39], v[220:223], v[164:167], v[36:39]
v_mfma_f32_16x16x32_bf16 v[40:43], v[220:223], v[168:171], v[40:43]
v_mfma_f32_16x16x32_bf16 v[44:47], v[220:223], v[172:175], v[44:47]
v_mfma_f32_16x16x32_bf16 v[48:51], v[220:223], v[176:179], v[48:51]
v_mfma_f32_16x16x32_bf16 v[52:55], v[220:223], v[180:183], v[52:55]
v_mfma_f32_16x16x32_bf16 v[56:59], v[220:223], v[184:187], v[56:59]
v_mfma_f32_16x16x32_bf16 v[60:63], v[220:223], v[188:191], v[60:63]
s_waitcnt lgkmcnt(0)
v_mfma_f32_16x16x32_bf16 v[0:3], v[224:227], v[132:135], v[0:3]
ds_read_b64_tr_b16 v[220:221], v230 offset:40960
ds_read_b64_tr_b16 v[222:223], v230 offset:41216
v_mfma_f32_16x16x32_bf16 v[4:7], v[224:227], v[136:139], v[4:7]
ds_read_b128 v[204:207], v229 offset:35200
ds_read_b128 v[208:211], v229 offset:35328
v_mfma_f32_16x16x32_bf16 v[8:11], v[224:227], v[140:143], v[8:11]
v_mfma_f32_16x16x32_bf16 v[12:15], v[224:227], v[144:147], v[12:15]
v_mfma_f32_16x16x32_bf16 v[16:19], v[224:227], v[148:151], v[16:19]
v_mfma_f32_16x16x32_bf16 v[20:23], v[224:227], v[152:155], v[20:23]
v_mfma_f32_16x16x32_bf16 v[24:27], v[224:227], v[156:159], v[24:27]
v_mfma_f32_16x16x32_bf16 v[28:31], v[224:227], v[160:163], v[28:31]
v_mfma_f32_16x16x32_bf16 v[32:35], v[224:227], v[164:167], v[32:35]
v_mfma_f32_16x16x32_bf16 v[36:39], v[224:227], v[168:171], v[36:39]
v_mfma_f32_16x16x32_bf16 v[40:43], v[224:227], v[172:175], v[40:43]
v_mfma_f32_16x16x32_bf16 v[44:47], v[224:227], v[176:179], v[44:47]
v_mfma_f32_16x16x32_bf16 v[48:51], v[224:227], v[180:183], v[48:51]
v_mfma_f32_16x16x32_bf16 v[52:55], v[224:227], v[184:187], v[52:55]
v_mfma_f32_16x16x32_bf16 v[56:59], v[224:227], v[188:191], v[56:59]
v_mfma_f32_16x16x32_bf16 v[60:63], v[224:227], v[192:195], v[60:63]
s_waitcnt lgkmcnt(0)
v_mfma_f32_16x16x32_bf16 v[0:3], v[220:223], v[136:139], v[0:3]
ds_read_b64_tr_b16 v[224:225], v230 offset:45056
ds_read_b64_tr_b16 v[226:227], v230 offset:45312
v_mfma_f32_16x16x32_bf16 v[4:7], v[220:223], v[140:143], v[4:7]
ds_read_b128 v[212:215], v229 offset:35456
v_mfma_f32_16x16x32_bf16 v[8:11], v[220:223], v[144:147], v[8:11]
v_mfma_f32_16x16x32_bf16 v[12:15], v[220:223], v[148:151], v[12:15]
v_mfma_f32_16x16x32_bf16 v[16:19], v[220:223], v[152:155], v[16:19]
v_mfma_f32_16x16x32_bf16 v[20:23], v[220:223], v[156:159], v[20:23]
v_mfma_f32_16x16x32_bf16 v[24:27], v[220:223], v[160:163], v[24:27]
v_mfma_f32_16x16x32_bf16 v[28:31], v[220:223], v[164:167], v[28:31]
v_mfma_f32_16x16x32_bf16 v[32:35], v[220:223], v[168:171], v[32:35]
v_mfma_f32_16x16x32_bf16 v[36:39], v[220:223], v[172:175], v[36:39]
v_mfma_f32_16x16x32_bf16 v[40:43], v[220:223], v[176:179], v[40:43]
v_mfma_f32_16x16x32_bf16 v[44:47], v[220:223], v[180:183], v[44:47]
v_mfma_f32_16x16x32_bf16 v[48:51], v[220:223], v[184:187], v[48:51]
v_mfma_f32_16x16x32_bf16 v[52:55], v[220:223], v[188:191], v[52:55]
v_mfma_f32_16x16x32_bf16 v[56:59], v[220:223], v[192:195], v[56:59]
v_mfma_f32_16x16x32_bf16 v[60:63], v[220:223], v[196:199], v[60:63]
s_waitcnt lgkmcnt(0)
s_barrier
v_mfma_f32_16x16x32_bf16 v[0:3], v[224:227], v[140:143], v[0:3]
ds_read_b64_tr_b16 v[220:221], v230 offset:49152
ds_read_b64_tr_b16 v[222:223], v230 offset:49408
v_mfma_f32_16x16x32_bf16 v[4:7], v[224:227], v[144:147], v[4:7]
ds_read_b128 v[128:131], v228 offset:0
ds_read_b128 v[132:135], v228 offset:128
v_mfma_f32_16x16x32_bf16 v[8:11], v[224:227], v[148:151], v[8:11]
ds_read_b128 v[136:139], v228 offset:256
v_mfma_f32_16x16x32_bf16 v[12:15], v[224:227], v[152:155], v[12:15]
v_mfma_f32_16x16x32_bf16 v[16:19], v[224:227], v[156:159], v[16:19]
v_mfma_f32_16x16x32_bf16 v[20:23], v[224:227], v[160:163], v[20:23]
v_mfma_f32_16x16x32_bf16 v[24:27], v[224:227], v[164:167], v[24:27]
v_mfma_f32_16x16x32_bf16 v[28:31], v[224:227], v[168:171], v[28:31]
v_mfma_f32_16x16x32_bf16 v[32:35], v[224:227], v[172:175], v[32:35]
v_mfma_f32_16x16x32_bf16 v[36:39], v[224:227], v[176:179], v[36:39]
v_mfma_f32_16x16x32_bf16 v[40:43], v[224:227], v[180:183], v[40:43]
v_mfma_f32_16x16x32_bf16 v[44:47], v[224:227], v[184:187], v[44:47]
v_mfma_f32_16x16x32_bf16 v[48:51], v[224:227], v[188:191], v[48:51]
v_mfma_f32_16x16x32_bf16 v[52:55], v[224:227], v[192:195], v[52:55]
v_mfma_f32_16x16x32_bf16 v[56:59], v[224:227], v[196:199], v[56:59]
v_mfma_f32_16x16x32_bf16 v[60:63], v[224:227], v[200:203], v[60:63]
s_waitcnt lgkmcnt(0)
v_mfma_f32_16x16x32_bf16 v[0:3], v[220:223], v[144:147], v[0:3]
ds_read_b64_tr_b16 v[224:225], v230 offset:53248
ds_read_b64_tr_b16 v[226:227], v230 offset:53504
v_mfma_f32_16x16x32_bf16 v[4:7], v[220:223], v[148:151], v[4:7]
ds_read_b128 v[140:143], v228 offset:384
v_mfma_f32_16x16x32_bf16 v[8:11], v[220:223], v[152:155], v[8:11]
v_mfma_f32_16x16x32_bf16 v[12:15], v[220:223], v[156:159], v[12:15]
v_mfma_f32_16x16x32_bf16 v[16:19], v[220:223], v[160:163], v[16:19]
v_mfma_f32_16x16x32_bf16 v[20:23], v[220:223], v[164:167], v[20:23]
v_mfma_f32_16x16x32_bf16 v[24:27], v[220:223], v[168:171], v[24:27]
v_mfma_f32_16x16x32_bf16 v[28:31], v[220:223], v[172:175], v[28:31]
v_mfma_f32_16x16x32_bf16 v[32:35], v[220:223], v[176:179], v[32:35]
v_mfma_f32_16x16x32_bf16 v[36:39], v[220:223], v[180:183], v[36:39]
v_mfma_f32_16x16x32_bf16 v[40:43], v[220:223], v[184:187], v[40:43]
v_mfma_f32_16x16x32_bf16 v[44:47], v[220:223], v[188:191], v[44:47]
v_mfma_f32_16x16x32_bf16 v[48:51], v[220:223], v[192:195], v[48:51]
v_mfma_f32_16x16x32_bf16 v[52:55], v[220:223], v[196:199], v[52:55]
v_mfma_f32_16x16x32_bf16 v[56:59], v[220:223], v[200:203], v[56:59]
v_mfma_f32_16x16x32_bf16 v[60:63], v[220:223], v[204:207], v[60:63]
s_waitcnt lgkmcnt(0)
v_mfma_f32_16x16x32_bf16 v[0:3], v[224:227], v[148:151], v[0:3]
ds_read_b64_tr_b16 v[248:249], v230 offset:57344
ds_read_b64_tr_b16 v[250:251], v230 offset:57600
v_mfma_f32_16x16x32_bf16 v[4:7], v[224:227], v[152:155], v[4:7]
ds_read_b128 v[144:147], v228 offset:512
v_mfma_f32_16x16x32_bf16 v[8:11], v[224:227], v[156:159], v[8:11]
v_mfma_f32_16x16x32_bf16 v[12:15], v[224:227], v[160:163], v[12:15]
v_mfma_f32_16x16x32_bf16 v[16:19], v[224:227], v[164:167], v[16:19]
v_mfma_f32_16x16x32_bf16 v[20:23], v[224:227], v[168:171], v[20:23]
v_mfma_f32_16x16x32_bf16 v[24:27], v[224:227], v[172:175], v[24:27]
v_mfma_f32_16x16x32_bf16 v[28:31], v[224:227], v[176:179], v[28:31]
v_mfma_f32_16x16x32_bf16 v[32:35], v[224:227], v[180:183], v[32:35]
v_mfma_f32_16x16x32_bf16 v[36:39], v[224:227], v[184:187], v[36:39]
v_mfma_f32_16x16x32_bf16 v[40:43], v[224:227], v[188:191], v[40:43]
v_mfma_f32_16x16x32_bf16 v[44:47], v[224:227], v[192:195], v[44:47]
v_mfma_f32_16x16x32_bf16 v[48:51], v[224:227], v[196:199], v[48:51]
v_mfma_f32_16x16x32_bf16 v[52:55], v[224:227], v[200:203], v[52:55]
v_mfma_f32_16x16x32_bf16 v[56:59], v[224:227], v[204:207], v[56:59]
v_mfma_f32_16x16x32_bf16 v[60:63], v[224:227], v[208:211], v[60:63]
s_waitcnt lgkmcnt(0)
s_barrier
v_mfma_f32_16x16x32_bf16 v[0:3], v[248:251], v[152:155], v[0:3]
ds_read_b64_tr_b16 v[220:221], v230 offset:0
ds_read_b64_tr_b16 v[222:223], v230 offset:256
v_mfma_f32_16x16x32_bf16 v[4:7], v[248:251], v[156:159], v[4:7]
ds_read_b128 v[148:151], v228 offset:640
ds_read_b128 v[152:155], v228 offset:768
v_mfma_f32_16x16x32_bf16 v[8:11], v[248:251], v[160:163], v[8:11]
ds_read_b128 v[156:159], v228 offset:896
ds_read_b128 v[160:163], v228 offset:1024
v_mfma_f32_16x16x32_bf16 v[12:15], v[248:251], v[164:167], v[12:15]
ds_read_b128 v[164:167], v228 offset:1152
v_mfma_f32_16x16x32_bf16 v[16:19], v[248:251], v[168:171], v[16:19]
ds_read_b128 v[168:171], v228 offset:1280
v_mfma_f32_16x16x32_bf16 v[20:23], v[248:251], v[172:175], v[20:23]
ds_read_b128 v[172:175], v228 offset:1408
v_mfma_f32_16x16x32_bf16 v[24:27], v[248:251], v[176:179], v[24:27]
ds_read_b128 v[176:179], v228 offset:1536
v_mfma_f32_16x16x32_bf16 v[28:31], v[248:251], v[180:183], v[28:31]
ds_read_b128 v[180:183], v228 offset:1664
v_mfma_f32_16x16x32_bf16 v[32:35], v[248:251], v[184:187], v[32:35]
ds_read_b128 v[184:187], v228 offset:1792
v_mfma_f32_16x16x32_bf16 v[36:39], v[248:251], v[188:191], v[36:39]
ds_read_b128 v[188:191], v228 offset:1920
v_mfma_f32_16x16x32_bf16 v[40:43], v[248:251], v[192:195], v[40:43]
v_mfma_f32_16x16x32_bf16 v[44:47], v[248:251], v[196:199], v[44:47]
v_mfma_f32_16x16x32_bf16 v[48:51], v[248:251], v[200:203], v[48:51]
v_mfma_f32_16x16x32_bf16 v[52:55], v[248:251], v[204:207], v[52:55]
s_add_u32 s43, s43, 1
v_mfma_f32_16x16x32_bf16 v[56:59], v[248:251], v[208:211], v[56:59]
s_cmp_lt_u32 s43, 8
v_mfma_f32_16x16x32_bf16 v[60:63], v[248:251], v[212:215], v[60:63]
s_cbranch_scc1 L_loopB
v_mov_b32_dpp v241, v64 row_shl:1 row_mask:0xf bank_mask:0xf
v_mov_b32_dpp v242, v65 row_shl:1 row_mask:0xf bank_mask:0xf
v_mov_b32_dpp v243, v66 row_shl:1 row_mask:0xf bank_mask:0xf
v_mov_b32_dpp v244, v67 row_shl:1 row_mask:0xf bank_mask:0xf
s_waitcnt vmcnt(0)
v_pk_add_f32 v[64:65], v[64:65], v[0:1]
v_pk_add_f32 v[66:67], v[66:67], v[2:3]
v_pk_add_f32 v[0:1], v[0:1], v[68:69]
v_pk_add_f32 v[2:3], v[2:3], v[70:71]
v_pk_add_f32 v[68:69], v[68:69], v[4:5]
v_pk_add_f32 v[70:71], v[70:71], v[6:7]
v_pk_add_f32 v[4:5], v[4:5], v[72:73]
v_pk_add_f32 v[6:7], v[6:7], v[74:75]
v_pk_add_f32 v[72:73], v[72:73], v[8:9]
v_pk_add_f32 v[74:75], v[74:75], v[10:11]
v_pk_add_f32 v[8:9], v[8:9], v[76:77]
v_pk_add_f32 v[10:11], v[10:11], v[78:79]
v_pk_add_f32 v[76:77], v[76:77], v[12:13]
v_pk_add_f32 v[78:79], v[78:79], v[14:15]
v_pk_add_f32 v[12:13], v[12:13], v[80:81]
v_pk_add_f32 v[14:15], v[14:15], v[82:83]
v_pk_add_f32 v[80:81], v[80:81], v[16:17]
v_pk_add_f32 v[82:83], v[82:83], v[18:19]
v_pk_add_f32 v[16:17], v[16:17], v[84:85]
v_pk_add_f32 v[18:19], v[18:19], v[86:87]
v_pk_add_f32 v[84:85], v[84:85], v[20:21]
v_pk_add_f32 v[86:87], v[86:87], v[22:23]
v_pk_add_f32 v[20:21], v[20:21], v[88:89]
v_pk_add_f32 v[22:23], v[22:23], v[90:91]
v_pk_add_f32 v[88:89], v[88:89], v[24:25]
v_pk_add_f32 v[90:91], v[90:91], v[26:27]
v_pk_add_f32 v[24:25], v[24:25], v[92:93]
v_pk_add_f32 v[26:27], v[26:27], v[94:95]
v_pk_add_f32 v[92:93], v[92:93], v[28:29]
v_pk_add_f32 v[94:95], v[94:95], v[30:31]
v_pk_add_f32 v[28:29], v[28:29], v[96:97]
v_pk_add_f32 v[30:31], v[30:31], v[98:99]
v_pk_add_f32 v[96:97], v[96:97], v[32:33]
v_pk_add_f32 v[98:99], v[98:99], v[34:35]
v_pk_add_f32 v[32:33], v[32:33], v[100:101]
v_pk_add_f32 v[34:35], v[34:35], v[102:103]
v_pk_add_f32 v[100:101], v[100:101], v[36:37]
v_pk_add_f32 v[102:103], v[102:103], v[38:39]
v_pk_add_f32 v[36:37], v[36:37], v[104:105]
v_pk_add_f32 v[38:39], v[38:39], v[106:107]
v_pk_add_f32 v[104:105], v[104:105], v[40:41]
v_pk_add_f32 v[106:107], v[106:107], v[42:43]
v_pk_add_f32 v[40:41], v[40:41], v[108:109]
v_pk_add_f32 v[42:43], v[42:43], v[110:111]
v_pk_add_f32 v[108:109], v[108:109], v[44:45]
v_pk_add_f32 v[110:111], v[110:111], v[46:47]
v_pk_add_f32 v[44:45], v[44:45], v[112:113]
v_pk_add_f32 v[46:47], v[46:47], v[114:115]
v_pk_add_f32 v[112:113], v[112:113], v[48:49]
v_pk_add_f32 v[114:115], v[114:115], v[50:51]
v_pk_add_f32 v[48:49], v[48:49], v[116:117]
v_pk_add_f32 v[50:51], v[50:51], v[118:119]
v_pk_add_f32 v[116:117], v[116:117], v[52:53]
v_pk_add_f32 v[118:119], v[118:119], v[54:55]
v_pk_add_f32 v[52:53], v[52:53], v[120:121]
v_pk_add_f32 v[54:55], v[54:55], v[122:123]
s_nop 3
v_pk_add_f32 v[120:121], v[120:121], v[56:57]
v_pk_add_f32 v[122:123], v[122:123], v[58:59]
v_pk_add_f32 v[56:57], v[56:57], v[124:125]
v_pk_add_f32 v[58:59], v[58:59], v[126:127]
v_pk_add_f32 v[124:125], v[124:125], v[60:61]
v_pk_add_f32 v[126:127], v[126:127], v[62:63]
v_add_f32 v60, v60, v241
v_add_f32 v61, v61, v242
v_add_f32 v62, v62, v243
v_add_f32 v63, v63, v244
s_nop 1
s_cmp_lg_u32 s41, 0
s_cbranch_scc1 L_loopQ0b
.p2align 4
L_loopQ0a:
s_waitcnt lgkmcnt(9)
v_mfma_f32_16x16x32_bf16 v[0:3], v[220:223], v[128:131], v[0:3]
ds_read_b64_tr_b16 v[224:225], v230 offset:4096
ds_read_b64_tr_b16 v[226:227], v230 offset:4352
v_mfma_f32_16x16x32_bf16 v[4:7], v[220:223], v[132:135], v[4:7]
ds_read_b128 v[192:195], v229 offset:0
ds_read_b128 v[196:199], v229 offset:128
v_mfma_f32_16x16x32_bf16 v[8:11], v[220:223], v[136:139], v[8:11]
ds_read_b128 v[200:203], v229 offset:256
v_mfma_f32_16x16x32_bf16 v[12:15], v[220:223], v[140:143], v[12:15]
v_mfma_f32_16x16x32_bf16 v[16:19], v[220:223], v[144:147], v[16:19]
v_mfma_f32_16x16x32_bf16 v[20:23], v[220:223], v[148:151], v[20:23]
v_mfma_f32_16x16x32_bf16 v[24:27], v[220:223], v[152:155], v[24:27]
s_waitcnt lgkmcnt(5)
v_mfma_f32_16x16x32_bf16 v[28:31], v[220:223], v[156:159], v[28:31]
v_mfma_f32_16x16x32_bf16 v[32:35], v[220:223], v[160:163], v[32:35]
v_mfma_f32_16x16x32_bf16 v[36:39], v[220:223], v[164:167], v[36:39]
v_mfma_f32_16x16x32_bf16 v[40:43], v[220:223], v[168:171], v[40:43]
v_mfma_f32_16x16x32_bf16 v[44:47], v[220:223], v[172:175], v[44:47]
v_mfma_f32_16x16x32_bf16 v[48:51], v[220:223], v[176:179], v[48:51]
v_mfma_f32_16x16x32_bf16 v[52:55], v[220:223], v[180:183], v[52:55]
v_mfma_f32_16x16x32_bf16 v[56:59], v[220:223], v[184:187], v[56:59]
v_mfma_f32_16x16x32_bf16 v[60:63], v[220:223], v[188:191], v[60:63]
s_waitcnt lgkmcnt(0)
v_mfma_f32_16x16x32_bf16 v[0:3], v[224:227], v[132:135], v[0:3]
ds_read_b64_tr_b16 v[220:221], v230 offset:8192
ds_read_b64_tr_b16 v[222:223], v230 offset:8448
v_mfma_f32_16x16x32_bf16 v[4:7], v[224:227], v[136:139], v[4:7]
ds_read_b128 v[204:207], v229 offset:384
ds_read_b128 v[208:211], v229 offset:512
v_mfma_f32_16x16x32_bf16 v[8:11], v[224:227], v[140:143], v[8:11]
v_mfma_f32_16x16x32_bf16 v[12:15], v[224:227], v[144:147], v[12:15]
v_mfma_f32_16x16x32_bf16 v[16:19], v[224:227], v[148:151], v[16:19]
ds_write_b128 v246, v[96:99] offset:0
v_mfma_f32_16x16x32_bf16 v[20:23], v[224:227], v[152:155], v[20:23]
v_mfma_f32_16x16x32_bf16 v[24:27], v[224:227], v[156:159], v[24:27]
v_mfma_f32_16x16x32_bf16 v[28:31], v[224:227], v[160:163], v[28:31]
v_mfma_f32_16x16x32_bf16 v[32:35], v[224:227], v[164:167], v[32:35]
v_mfma_f32_16x16x32_bf16 v[36:39], v[224:227], v[168:171], v[36:39]
v_mfma_f32_16x16x32_bf16 v[40:43], v[224:227], v[172:175], v[40:43]
ds_write_b128 v246, v[100:103] offset:1024
v_mfma_f32_16x16x32_bf16 v[44:47], v[224:227], v[176:179], v[44:47]
v_mfma_f32_16x16x32_bf16 v[48:51], v[224:227], v[180:183], v[48:51]
v_mfma_f32_16x16x32_bf16 v[52:55], v[224:227], v[184:187], v[52:55]
v_mfma_f32_16x16x32_bf16 v[56:59], v[224:227], v[188:191], v[56:59]
v_mfma_f32_16x16x32_bf16 v[60:63], v[224:227], v[192:195], v[60:63]
s_waitcnt lgkmcnt(0)
v_mfma_f32_16x16x32_bf16 v[0:3], v[220:223], v[136:139], v[0:3]
ds_read_b64_tr_b16 v[224:225], v230 offset:12288
ds_read_b64_tr_b16 v[226:227], v230 offset:12544
v_mfma_f32_16x16x32_bf16 v[4:7], v[220:223], v[140:143], v[4:7]
ds_read_b128 v[212:215], v229 offset:640
ds_read_b128 v[216:219], v229 offset:768
v_mfma_f32_16x16x32_bf16 v[8:11], v[220:223], v[144:147], v[8:11]
v_mfma_f32_16x16x32_bf16 v[12:15], v[220:223], v[148:151], v[12:15]
v_mfma_f32_16x16x32_bf16 v[16:19], v[220:223], v[152:155], v[16:19]
ds_write_b128 v246, v[104:107] offset:2048
v_mfma_f32_16x16x32_bf16 v[20:23], v[220:223], v[156:159], v[20:23]
v_mfma_f32_16x16x32_bf16 v[24:27], v[220:223], v[160:163], v[24:27]
v_mfma_f32_16x16x32_bf16 v[28:31], v[220:223], v[164:167], v[28:31]
v_mfma_f32_16x16x32_bf16 v[32:35], v[220:223], v[168:171], v[32:35]
v_mfma_f32_16x16x32_bf16 v[36:39], v[220:223], v[172:175], v[36:39]
v_mfma_f32_16x16x32_bf16 v[40:43], v[220:223], v[176:179], v[40:43]
ds_write_b128 v246, v[108:111] offset:3072
v_mfma_f32_16x16x32_bf16 v[44:47], v[220:223], v[180:183], v[44:47]
v_mfma_f32_16x16x32_bf16 v[48:51], v[220:223], v[184:187], v[48:51]
v_mfma_f32_16x16x32_bf16 v[52:55], v[220:223], v[188:191], v[52:55]
v_mfma_f32_16x16x32_bf16 v[56:59], v[220:223], v[192:195], v[56:59]
v_mfma_f32_16x16x32_bf16 v[60:63], v[220:223], v[196:199], v[60:63]
s_waitcnt lgkmcnt(0)
s_barrier
v_mfma_f32_16x16x32_bf16 v[0:3], v[224:227], v[140:143], v[0:3]
ds_read_b64_tr_b16 v[220:221], v230 offset:16384
ds_read_b64_tr_b16 v[222:223], v230 offset:16640
v_mfma_f32_16x16x32_bf16 v[4:7], v[224:227], v[144:147], v[4:7]
ds_read_b128 v[128:131], v228 offset:34816
ds_read_b128 v[132:135], v228 offset:34944
v_mfma_f32_16x16x32_bf16 v[8:11], v[224:227], v[148:151], v[8:11]
ds_read_b128 v[136:139], v228 offset:35072
v_mfma_f32_16x16x32_bf16 v[12:15], v[224:227], v[152:155], v[12:15]
v_mfma_f32_16x16x32_bf16 v[16:19], v[224:227], v[156:159], v[16:19]
v_mfma_f32_16x16x32_bf16 v[20:23], v[224:227], v[160:163], v[20:23]
v_mfma_f32_16x16x32_bf16 v[24:27], v[224:227], v[164:167], v[24:27]
v_mfma_f32_16x16x32_bf16 v[28:31], v[224:227], v[168:171], v[28:31]
v_mfma_f32_16x16x32_bf16 v[32:35], v[224:227], v[172:175], v[32:35]
v_mfma_f32_16x16x32_bf16 v[36:39], v[224:227], v[176:179], v[36:39]
v_mfma_f32_16x16x32_bf16 v[40:43], v[224:227], v[180:183], v[40:43]
v_mfma_f32_16x16x32_bf16 v[44:47], v[224:227], v[184:187], v[44:47]
v_mfma_f32_16x16x32_bf16 v[48:51], v[224:227], v[188:191], v[48:51]
v_mfma_f32_16x16x32_bf16 v[52:55], v[224:227], v[192:195], v[52:55]
v_mfma_f32_16x16x32_bf16 v[56:59], v[224:227], v[196:199], v[56:59]
v_mfma_f32_16x16x32_bf16 v[60:63], v[224:227], v[200:203], v[60:63]
s_waitcnt lgkmcnt(0)
v_mfma_f32_16x16x32_bf16 v[0:3], v[220:223], v[144:147], v[0:3]
ds_read_b64_tr_b16 v[224:225], v230 offset:20480
ds_read_b64_tr_b16 v[226:227], v230 offset:20736
v_mfma_f32_16x16x32_bf16 v[4:7], v[220:223], v[148:151], v[4:7]
ds_read_b128 v[140:143], v228 offset:35200
v_mfma_f32_16x16x32_bf16 v[8:11], v[220:223], v[152:155], v[8:11]
v_mfma_f32_16x16x32_bf16 v[12:15], v[220:223], v[156:159], v[12:15]
v_mfma_f32_16x16x32_bf16 v[16:19], v[220:223], v[160:163], v[16:19]
ds_read_b128 v[96:99], v247 offset:0
v_mfma_f32_16x16x32_bf16 v[20:23], v[220:223], v[164:167], v[20:23]
v_mfma_f32_16x16x32_bf16 v[24:27], v[220:223], v[168:171], v[24:27]
v_mfma_f32_16x16x32_bf16 v[28:31], v[220:223], v[172:175], v[28:31]
v_mfma_f32_16x16x32_bf16 v[32:35], v[220:223], v[176:179], v[32:35]
v_mfma_f32_16x16x32_bf16 v[36:39], v[220:223], v[180:183], v[36:39]
v_mfma_f32_16x16x32_bf16 v[40:43], v[220:223], v[184:187], v[40:43]
ds_read_b128 v[100:103], v247 offset:1024
v_mfma_f32_16x16x32_bf16 v[44:47], v[220:223], v[188:191], v[44:47]
v_mfma_f32_16x16x32_bf16 v[48:51], v[220:223], v[192:195], v[48:51]
v_mfma_f32_16x16x32_bf16 v[52:55], v[220:223], v[196:199], v[52:55]
v_mfma_f32_16x16x32_bf16 v[56:59], v[220:223], v[200:203], v[56:59]
v_mfma_f32_16x16x32_bf16 v[60:63], v[220:223], v[204:207], v[60:63]
s_waitcnt lgkmcnt(0)
v_mfma_f32_16x16x32_bf16 v[0:3], v[224:227], v[148:151], v[0:3]
ds_read_b64_tr_b16 v[220:221], v230 offset:24576
ds_read_b64_tr_b16 v[222:223], v230 offset:24832
v_mfma_f32_16x16x32_bf16 v[4:7], v[224:227], v[152:155], v[4:7]
ds_read_b128 v[144:147], v228 offset:35328
v_mfma_f32_16x16x32_bf16 v[8:11], v[224:227], v[156:159], v[8:11]
v_mfma_f32_16x16x32_bf16 v[12:15], v[224:227], v[160:163], v[12:15]
v_mfma_f32_16x16x32_bf16 v[16:19], v[224:227], v[164:167], v[16:19]
ds_read_b128 v[104:107], v247 offset:2048
v_mfma_f32_16x16x32_bf16 v[20:23], v[224:227], v[168:171], v[20:23]
v_mfma_f32_16x16x32_bf16 v[24:27], v[224:227], v[172:175], v[24:27]
v_mfma_f32_16x16x32_bf16 v[28:31], v[224:227], v[176:179], v[28:31]
v_mfma_f32_16x16x32_bf16 v[32:35], v[224:227], v[180:183], v[32:35]
v_mfma_f32_16x16x32_bf16 v[36:39], v[224:227], v[184:187], v[36:39]
v_mfma_f32_16x16x32_bf16 v[40:43], v[224:227], v[188:191], v[40:43]
ds_read_b128 v[108:111], v247 offset:3072
v_mfma_f32_16x16x32_bf16 v[44:47], v[224:227], v[192:195], v[44:47]
v_mfma_f32_16x16x32_bf16 v[48:51], v[224:227], v[196:199], v[48:51]
v_mfma_f32_16x16x32_bf16 v[52:55], v[224:227], v[200:203], v[52:55]
v_mfma_f32_16x16x32_bf16 v[56:59], v[224:227], v[204:207], v[56:59]
v_mfma_f32_16x16x32_bf16 v[60:63], v[224:227], v[208:211], v[60:63]
s_waitcnt lgkmcnt(0)
v_mfma_f32_16x16x32_bf16 v[0:3], v[220:223], v[152:155], v[0:3]
ds_read_b64_tr_b16 v[224:225], v230 offset:28672
ds_read_b64_tr_b16 v[226:227], v230 offset:28928
v_mfma_f32_16x16x32_bf16 v[4:7], v[220:223], v[156:159], v[4:7]
ds_read_b128 v[148:151], v228 offset:35456
v_mfma_f32_16x16x32_bf16 v[8:11], v[220:223], v[160:163], v[8:11]
v_mfma_f32_16x16x32_bf16 v[12:15], v[220:223], v[164:167], v[12:15]
v_mfma_f32_16x16x32_bf16 v[16:19], v[220:223], v[168:171], v[16:19]
v_mfma_f32_16x16x32_bf16 v[20:23], v[220:223], v[172:175], v[20:23]
v_mfma_f32_16x16x32_bf16 v[24:27], v[220:223], v[176:179], v[24:27]
v_mfma_f32_16x16x32_bf16 v[28:31], v[220:223], v[180:183], v[28:31]
v_mfma_f32_16x16x32_bf16 v[32:35], v[220:223], v[184:187], v[32:35]
v_mfma_f32_16x16x32_bf16 v[36:39], v[220:223], v[188:191], v[36:39]
v_mfma_f32_16x16x32_bf16 v[40:43], v[220:223], v[192:195], v[40:43]
v_mfma_f32_16x16x32_bf16 v[44:47], v[220:223], v[196:199], v[44:47]
v_mfma_f32_16x16x32_bf16 v[48:51], v[220:223], v[200:203], v[48:51]
v_mfma_f32_16x16x32_bf16 v[52:55], v[220:223], v[204:207], v[52:55]
v_mfma_f32_16x16x32_bf16 v[56:59], v[220:223], v[208:211], v[56:59]
v_mfma_f32_16x16x32_bf16 v[60:63], v[220:223], v[212:215], v[60:63]
s_waitcnt lgkmcnt(0)
s_barrier
v_mfma_f32_16x16x32_bf16 v[0:3], v[224:227], v[156:159], v[0:3]
ds_read_b64_tr_b16 v[220:221], v230 offset:32768
ds_read_b64_tr_b16 v[222:223], v230 offset:33024
v_mfma_f32_16x16x32_bf16 v[4:7], v[224:227], v[160:163], v[4:7]
ds_read_b128 v[152:155], v228 offset:35584
ds_read_b128 v[156:159], v228 offset:35712
v_mfma_f32_16x16x32_bf16 v[8:11], v[224:227], v[164:167], v[8:11]
ds_read_b128 v[160:163], v228 offset:35840
ds_read_b128 v[164:167], v228 offset:35968
v_mfma_f32_16x16x32_bf16 v[12:15], v[224:227], v[168:171], v[12:15]
ds_read_b128 v[168:171], v228 offset:36096
v_mfma_f32_16x16x32_bf16 v[16:19], v[224:227], v[172:175], v[16:19]
ds_read_b128 v[172:175], v228 offset:36224
v_mfma_f32_16x16x32_bf16 v[20:23], v[224:227], v[176:179], v[20:23]
ds_read_b128 v[176:179], v228 offset:36352
v_mfma_f32_16x16x32_bf16 v[24:27], v[224:227], v[180:183], v[24:27]
ds_read_b128 v[180:183], v228 offset:36480
v_mfma_f32_16x16x32_bf16 v[28:31], v[224:227], v[184:187], v[28:31]
ds_read_b128 v[184:187], v228 offset:36608
v_mfma_f32_16x16x32_bf16 v[32:35], v[224:227], v[188:191], v[32:35]
ds_read_b128 v[188:191], v228 offset:36736
v_mfma_f32_16x16x32_bf16 v[36:39], v[224:227], v[192:195], v[36:39]
v_mfma_f32_16x16x32_bf16 v[40:43], v[224:227], v[196:199], v[40:43]
v_mfma_f32_16x16x32_bf16 v[44:47], v[224:227], v[200:203], v[44:47]
v_mfma_f32_16x16x32_bf16 v[48:51], v[224:227], v[204:207], v[48:51]
v_mfma_f32_16x16x32_bf16 v[52:55], v[224:227], v[208:211], v[52:55]
v_mfma_f32_16x16x32_bf16 v[56:59], v[224:227], v[212:215], v[56:59]
v_mfma_f32_16x16x32_bf16 v[60:63], v[224:227], v[216:219], v[60:63]
s_waitcnt lgkmcnt(9)
v_mfma_f32_16x16x32_bf16 v[0:3], v[220:223], v[128:131], v[0:3]
ds_read_b64_tr_b16 v[224:225], v230 offset:36864
ds_read_b64_tr_b16 v[226:227], v230 offset:37120
v_mfma_f32_16x16x32_bf16 v[4:7], v[220:223], v[132:135], v[4:7]
ds_read_b128 v[192:195], v229 offset:34816
ds_read_b128 v[196:199], v229 offset:34944
v_mfma_f32_16x16x32_bf16 v[8:11], v[220:223], v[136:139], v[8:11]
ds_read_b128 v[200:203], v229 offset:35072
v_mfma_f32_16x16x32_bf16 v[12:15], v[220:223], v[140:143], v[12:15]
v_mfma_f32_16x16x32_bf16 v[16:19], v[220:223], v[144:147], v[16:19]
v_mfma_f32_16x16x32_bf16 v[20:23], v[220:223], v[148:151], v[20:23]
v_mfma_f32_16x16x32_bf16 v[24:27], v[220:223], v[152:155], v[24:27]
s_waitcnt lgkmcnt(5)
v_mfma_f32_16x16x32_bf16 v[28:31], v[220:223], v[156:159], v[28:31]
v_mfma_f32_16x16x32_bf16 v[32:35], v[220:223], v[160:163], v[32:35]
v_mfma_f32_16x16x32_bf16 v[36:39], v[220:223], v[164:167], v[36:39]
v_mfma_f32_16x16x32_bf16 v[40:43], v[220:223], v[168:171], v[40:43]
v_mfma_f32_16x16x32_bf16 v[44:47], v[220:223], v[172:175], v[44:47]
v_mfma_f32_16x16x32_bf16 v[48:51], v[220:223], v[176:179], v[48:51]
v_mfma_f32_16x16x32_bf16 v[52:55], v[220:223], v[180:183], v[52:55]
v_mfma_f32_16x16x32_bf16 v[56:59], v[220:223], v[184:187], v[56:59]
v_mfma_f32_16x16x32_bf16 v[60:63], v[220:223], v[188:191], v[60:63]
s_waitcnt lgkmcnt(0)
v_mfma_f32_16x16x32_bf16 v[0:3], v[224:227], v[132:135], v[0:3]
ds_read_b64_tr_b16 v[220:221], v230 offset:40960
ds_read_b64_tr_b16 v[222:223], v230 offset:41216
v_mfma_f32_16x16x32_bf16 v[4:7], v[224:227], v[136:139], v[4:7]
ds_read_b128 v[204:207], v229 offset:35200
ds_read_b128 v[208:211], v229 offset:35328
v_mfma_f32_16x16x32_bf16 v[8:11], v[224:227], v[140:143], v[8:11]
v_mfma_f32_16x16x32_bf16 v[12:15], v[224:227], v[144:147], v[12:15]
v_mfma_f32_16x16x32_bf16 v[16:19], v[224:227], v[148:151], v[16:19]
ds_write_b128 v246, v[112:115] offset:0
v_mfma_f32_16x16x32_bf16 v[20:23], v[224:227], v[152:155], v[20:23]
v_mfma_f32_16x16x32_bf16 v[24:27], v[224:227], v[156:159], v[24:27]
v_mfma_f32_16x16x32_bf16 v[28:31], v[224:227], v[160:163], v[28:31]
v_mfma_f32_16x16x32_bf16 v[32:35], v[224:227], v[164:167], v[32:35]
v_mfma_f32_16x16x32_bf16 v[36:39], v[224:227], v[168:171], v[36:39]
v_mfma_f32_16x16x32_bf16 v[40:43], v[224:227], v[172:175], v[40:43]
ds_write_b128 v246, v[116:119] offset:1024
v_mfma_f32_16x16x32_bf16 v[44:47], v[224:227], v[176:179], v[44:47]
v_mfma_f32_16x16x32_bf16 v[48:51], v[224:227], v[180:183], v[48:51]
v_mfma_f32_16x16x32_bf16 v[52:55], v[224:227], v[184:187], v[52:55]
v_mfma_f32_16x16x32_bf16 v[56:59], v[224:227], v[188:191], v[56:59]
v_mfma_f32_16x16x32_bf16 v[60:63], v[224:227], v[192:195], v[60:63]
s_waitcnt lgkmcnt(0)
v_mfma_f32_16x16x32_bf16 v[0:3], v[220:223], v[136:139], v[0:3]
ds_read_b64_tr_b16 v[224:225], v230 offset:45056
ds_read_b64_tr_b16 v[226:227], v230 offset:45312
v_mfma_f32_16x16x32_bf16 v[4:7], v[220:223], v[140:143], v[4:7]
ds_read_b128 v[212:215], v229 offset:35456
ds_read_b128 v[216:219], v229 offset:35584
v_mfma_f32_16x16x32_bf16 v[8:11], v[220:223], v[144:147], v[8:11]
v_mfma_f32_16x16x32_bf16 v[12:15], v[220:223], v[148:151], v[12:15]
v_mfma_f32_16x16x32_bf16 v[16:19], v[220:223], v[152:155], v[16:19]
ds_write_b128 v246, v[120:123] offset:2048
v_mfma_f32_16x16x32_bf16 v[20:23], v[220:223], v[156:159], v[20:23]
v_mfma_f32_16x16x32_bf16 v[24:27], v[220:223], v[160:163], v[24:27]
v_mfma_f32_16x16x32_bf16 v[28:31], v[220:223], v[164:167], v[28:31]
v_mfma_f32_16x16x32_bf16 v[32:35], v[220:223], v[168:171], v[32:35]
v_mfma_f32_16x16x32_bf16 v[36:39], v[220:223], v[172:175], v[36:39]
v_mfma_f32_16x16x32_bf16 v[40:43], v[220:223], v[176:179], v[40:43]
ds_write_b128 v246, v[124:127] offset:3072
v_mfma_f32_16x16x32_bf16 v[44:47], v[220:223], v[180:183], v[44:47]
v_mfma_f32_16x16x32_bf16 v[48:51], v[220:223], v[184:187], v[48:51]
v_mfma_f32_16x16x32_bf16 v[52:55], v[220:223], v[188:191], v[52:55]
v_mfma_f32_16x16x32_bf16 v[56:59], v[220:223], v[192:195], v[56:59]
v_mfma_f32_16x16x32_bf16 v[60:63], v[220:223], v[196:199], v[60:63]
s_waitcnt lgkmcnt(0)
s_barrier
v_mfma_f32_16x16x32_bf16 v[0:3], v[224:227], v[140:143], v[0:3]
ds_read_b64_tr_b16 v[220:221], v230 offset:49152
ds_read_b64_tr_b16 v[222:223], v230 offset:49408
v_mfma_f32_16x16x32_bf16 v[4:7], v[224:227], v[144:147], v[4:7]
ds_read_b128 v[128:131], v228 offset:0
ds_read_b128 v[132:135], v228 offset:128
v_mfma_f32_16x16x32_bf16 v[8:11], v[224:227], v[148:151], v[8:11]
ds_read_b128 v[136:139], v228 offset:256
v_mfma_f32_16x16x32_bf16 v[12:15], v[224:227], v[152:155], v[12:15]
v_mfma_f32_16x16x32_bf16 v[16:19], v[224:227], v[156:159], v[16:19]
v_mfma_f32_16x16x32_bf16 v[20:23], v[224:227], v[160:163], v[20:23]
v_mfma_f32_16x16x32_bf16 v[24:27], v[224:227], v[164:167], v[24:27]
v_mfma_f32_16x16x32_bf16 v[28:31], v[224:227], v[168:171], v[28:31]
v_mfma_f32_16x16x32_bf16 v[32:35], v[224:227], v[172:175], v[32:35]
v_mfma_f32_16x16x32_bf16 v[36:39], v[224:227], v[176:179], v[36:39]
v_mfma_f32_16x16x32_bf16 v[40:43], v[224:227], v[180:183], v[40:43]
v_mfma_f32_16x16x32_bf16 v[44:47], v[224:227], v[184:187], v[44:47]
v_mfma_f32_16x16x32_bf16 v[48:51], v[224:227], v[188:191], v[48:51]
v_mfma_f32_16x16x32_bf16 v[52:55], v[224:227], v[192:195], v[52:55]
v_mfma_f32_16x16x32_bf16 v[56:59], v[224:227], v[196:199], v[56:59]
v_mfma_f32_16x16x32_bf16 v[60:63], v[224:227], v[200:203], v[60:63]
s_waitcnt lgkmcnt(0)
v_mfma_f32_16x16x32_bf16 v[0:3], v[220:223], v[144:147], v[0:3]
ds_read_b64_tr_b16 v[224:225], v230 offset:53248
ds_read_b64_tr_b16 v[226:227], v230 offset:53504
v_mfma_f32_16x16x32_bf16 v[4:7], v[220:223], v[148:151], v[4:7]
ds_read_b128 v[140:143], v228 offset:384
v_mfma_f32_16x16x32_bf16 v[8:11], v[220:223], v[152:155], v[8:11]
v_mfma_f32_16x16x32_bf16 v[12:15], v[220:223], v[156:159], v[12:15]
v_mfma_f32_16x16x32_bf16 v[16:19], v[220:223], v[160:163], v[16:19]
ds_read_b128 v[112:115], v247 offset:0
v_mfma_f32_16x16x32_bf16 v[20:23], v[220:223], v[164:167], v[20:23]
v_mfma_f32_16x16x32_bf16 v[24:27], v[220:223], v[168:171], v[24:27]
v_mfma_f32_16x16x32_bf16 v[28:31], v[220:223], v[172:175], v[28:31]
v_mfma_f32_16x16x32_bf16 v[32:35], v[220:223], v[176:179], v[32:35]
v_mfma_f32_16x16x32_bf16 v[36:39], v[220:223], v[180:183], v[36:39]
v_mfma_f32_16x16x32_bf16 v[40:43], v[220:223], v[184:187], v[40:43]
ds_read_b128 v[116:119], v247 offset:1024
v_mfma_f32_16x16x32_bf16 v[44:47], v[220:223], v[188:191], v[44:47]
v_mfma_f32_16x16x32_bf16 v[48:51], v[220:223], v[192:195], v[48:51]
v_mfma_f32_16x16x32_bf16 v[52:55], v[220:223], v[196:199], v[52:55]
v_mfma_f32_16x16x32_bf16 v[56:59], v[220:223], v[200:203], v[56:59]
v_mfma_f32_16x16x32_bf16 v[60:63], v[220:223], v[204:207], v[60:63]
s_waitcnt lgkmcnt(0)
v_mfma_f32_16x16x32_bf16 v[0:3], v[224:227], v[148:151], v[0:3]
ds_read_b64_tr_b16 v[248:249], v230 offset:57344
ds_read_b64_tr_b16 v[250:251], v230 offset:57600
v_mfma_f32_16x16x32_bf16 v[4:7], v[224:227], v[152:155], v[4:7]
ds_read_b128 v[144:147], v228 offset:512
v_mfma_f32_16x16x32_bf16 v[8:11], v[224:227], v[156:159], v[8:11]
v_mfma_f32_16x16x32_bf16 v[12:15], v[224:227], v[160:163], v[12:15]
v_mfma_f32_16x16x32_bf16 v[16:19], v[224:227], v[164:167], v[16:19]
ds_read_b128 v[120:123], v247 offset:2048
v_mfma_f32_16x16x32_bf16 v[20:23], v[224:227], v[168:171], v[20:23]
v_mfma_f32_16x16x32_bf16 v[24:27], v[224:227], v[172:175], v[24:27]
v_mfma_f32_16x16x32_bf16 v[28:31], v[224:227], v[176:179], v[28:31]
v_mfma_f32_16x16x32_bf16 v[32:35], v[224:227], v[180:183], v[32:35]
v_mfma_f32_16x16x32_bf16 v[36:39], v[224:227], v[184:187], v[36:39]
v_mfma_f32_16x16x32_bf16 v[40:43], v[224:227], v[188:191], v[40:43]
ds_read_b128 v[124:127], v247 offset:3072
v_mfma_f32_16x16x32_bf16 v[44:47], v[224:227], v[192:195], v[44:47]
v_mfma_f32_16x16x32_bf16 v[48:51], v[224:227], v[196:199], v[48:51]
v_mfma_f32_16x16x32_bf16 v[52:55], v[224:227], v[200:203], v[52:55]
v_mfma_f32_16x16x32_bf16 v[56:59], v[224:227], v[204:207], v[56:59]
v_mfma_f32_16x16x32_bf16 v[60:63], v[224:227], v[208:211], v[60:63]
s_waitcnt lgkmcnt(0)
v_mfma_f32_16x16x32_bf16 v[0:3], v[248:251], v[152:155], v[0:3]
ds_read_b64_tr_b16 v[224:225], v230 offset:61440
ds_read_b64_tr_b16 v[226:227], v230 offset:61696
v_mfma_f32_16x16x32_bf16 v[4:7], v[248:251], v[156:159], v[4:7]
ds_read_b128 v[148:151], v228 offset:640
v_mfma_f32_16x16x32_bf16 v[8:11], v[248:251], v[160:163], v[8:11]
v_mfma_f32_16x16x32_bf16 v[12:15], v[248:251], v[164:167], v[12:15]
v_mfma_f32_16x16x32_bf16 v[16:19], v[248:251], v[168:171], v[16:19]
v_mfma_f32_16x16x32_bf16 v[20:23], v[248:251], v[172:175], v[20:23]
v_mfma_f32_16x16x32_bf16 v[24:27], v[248:251], v[176:179], v[24:27]
v_mfma_f32_16x16x32_bf16 v[28:31], v[248:251], v[180:183], v[28:31]
v_mfma_f32_16x16x32_bf16 v[32:35], v[248:251], v[184:187], v[32:35]
v_mfma_f32_16x16x32_bf16 v[36:39], v[248:251], v[188:191], v[36:39]
v_mfma_f32_16x16x32_bf16 v[40:43], v[248:251], v[192:195], v[40:43]
v_mfma_f32_16x16x32_bf16 v[44:47], v[248:251], v[196:199], v[44:47]
v_mfma_f32_16x16x32_bf16 v[48:51], v[248:251], v[200:203], v[48:51]
v_mfma_f32_16x16x32_bf16 v[52:55], v[248:251], v[204:207], v[52:55]
v_mfma_f32_16x16x32_bf16 v[56:59], v[248:251], v[208:211], v[56:59]
v_mfma_f32_16x16x32_bf16 v[60:63], v[248:251], v[212:215], v[60:63]
s_waitcnt lgkmcnt(0)
s_barrier
v_mfma_f32_16x16x32_bf16 v[0:3], v[224:227], v[156:159], v[0:3]
ds_read_b64_tr_b16 v[220:221], v230 offset:0
ds_read_b64_tr_b16 v[222:223], v230 offset:256
v_mfma_f32_16x16x32_bf16 v[4:7], v[224:227], v[160:163], v[4:7]
ds_read_b128 v[152:155], v228 offset:768
ds_read_b128 v[156:159], v228 offset:896
v_mfma_f32_16x16x32_bf16 v[8:11], v[224:227], v[164:167], v[8:11]
ds_read_b128 v[160:163], v228 offset:1024
ds_read_b128 v[164:167], v228 offset:1152
v_mfma_f32_16x16x32_bf16 v[12:15], v[224:227], v[168:171], v[12:15]
ds_read_b128 v[168:171], v228 offset:1280
v_mfma_f32_16x16x32_bf16 v[16:19], v[224:227], v[172:175], v[16:19]
ds_read_b128 v[172:175], v228 offset:1408
v_mfma_f32_16x16x32_bf16 v[20:23], v[224:227], v[176:179], v[20:23]
ds_read_b128 v[176:179], v228 offset:1536
v_mfma_f32_16x16x32_bf16 v[24:27], v[224:227], v[180:183], v[24:27]
ds_read_b128 v[180:183], v228 offset:1664
v_mfma_f32_16x16x32_bf16 v[28:31], v[224:227], v[184:187], v[28:31]
ds_read_b128 v[184:187], v228 offset:1792
v_mfma_f32_16x16x32_bf16 v[32:35], v[224:227], v[188:191], v[32:35]
ds_read_b128 v[188:191], v228 offset:1920
v_mfma_f32_16x16x32_bf16 v[36:39], v[224:227], v[192:195], v[36:39]
v_mfma_f32_16x16x32_bf16 v[40:43], v[224:227], v[196:199], v[40:43]
v_mfma_f32_16x16x32_bf16 v[44:47], v[224:227], v[200:203], v[44:47]
v_mfma_f32_16x16x32_bf16 v[48:51], v[224:227], v[204:207], v[48:51]
v_mfma_f32_16x16x32_bf16 v[52:55], v[224:227], v[208:211], v[52:55]
s_add_u32 s43, s43, 1
v_mfma_f32_16x16x32_bf16 v[56:59], v[224:227], v[212:215], v[56:59]
v_mfma_f32_16x16x32_bf16 v[60:63], v[224:227], v[216:219], v[60:63]
s_branch L_loopQ1
.p2align 4
L_loopQ0b:
s_waitcnt lgkmcnt(9)
v_mfma_f32_16x16x32_bf16 v[0:3], v[220:223], v[128:131], v[0:3]
ds_read_b64_tr_b16 v[224:225], v230 offset:4096
ds_read_b64_tr_b16 v[226:227], v230 offset:4352
v_mfma_f32_16x16x32_bf16 v[4:7], v[220:223], v[132:135], v[4:7]
ds_read_b128 v[192:195], v229 offset:0
ds_read_b128 v[196:199], v229 offset:128
v_mfma_f32_16x16x32_bf16 v[8:11], v[220:223], v[136:139], v[8:11]
ds_read_b128 v[200:203], v229 offset:256
v_mfma_f32_16x16x32_bf16 v[12:15], v[220:223], v[140:143], v[12:15]
v_mfma_f32_16x16x32_bf16 v[16:19], v[220:223], v[144:147], v[16:19]
v_mfma_f32_16x16x32_bf16 v[20:23], v[220:223], v[148:151], v[20:23]
v_mfma_f32_16x16x32_bf16 v[24:27], v[220:223], v[152:155], v[24:27]
s_waitcnt lgkmcnt(5)
v_mfma_f32_16x16x32_bf16 v[28:31], v[220:223], v[156:159], v[28:31]
v_mfma_f32_16x16x32_bf16 v[32:35], v[220:223], v[160:163], v[32:35]
v_mfma_f32_16x16x32_bf16 v[36:39], v[220:223], v[164:167], v[36:39]
v_mfma_f32_16x16x32_bf16 v[40:43], v[220:223], v[168:171], v[40:43]
v_mfma_f32_16x16x32_bf16 v[44:47], v[220:223], v[172:175], v[44:47]
v_mfma_f32_16x16x32_bf16 v[48:51], v[220:223], v[176:179], v[48:51]
v_mfma_f32_16x16x32_bf16 v[52:55], v[220:223], v[180:183], v[52:55]
v_mfma_f32_16x16x32_bf16 v[56:59], v[220:223], v[184:187], v[56:59]
v_mfma_f32_16x16x32_bf16 v[60:63], v[220:223], v[188:191], v[60:63]
s_waitcnt lgkmcnt(0)
v_mfma_f32_16x16x32_bf16 v[0:3], v[224:227], v[132:135], v[0:3]
ds_read_b64_tr_b16 v[220:221], v230 offset:8192
ds_read_b64_tr_b16 v[222:223], v230 offset:8448
v_mfma_f32_16x16x32_bf16 v[4:7], v[224:227], v[136:139], v[4:7]
ds_read_b128 v[204:207], v229 offset:384
ds_read_b128 v[208:211], v229 offset:512
v_mfma_f32_16x16x32_bf16 v[8:11], v[224:227], v[140:143], v[8:11]
v_mfma_f32_16x16x32_bf16 v[12:15], v[224:227], v[144:147], v[12:15]
v_mfma_f32_16x16x32_bf16 v[16:19], v[224:227], v[148:151], v[16:19]
ds_write_b128 v246, v[64:67] offset:0
v_mfma_f32_16x16x32_bf16 v[20:23], v[224:227], v[152:155], v[20:23]
v_mfma_f32_16x16x32_bf16 v[24:27], v[224:227], v[156:159], v[24:27]
v_mfma_f32_16x16x32_bf16 v[28:31], v[224:227], v[160:163], v[28:31]
v_mfma_f32_16x16x32_bf16 v[32:35], v[224:227], v[164:167], v[32:35]
v_mfma_f32_16x16x32_bf16 v[36:39], v[224:227], v[168:171], v[36:39]
v_mfma_f32_16x16x32_bf16 v[40:43], v[224:227], v[172:175], v[40:43]
ds_write_b128 v246, v[68:71] offset:1024
v_mfma_f32_16x16x32_bf16 v[44:47], v[224:227], v[176:179], v[44:47]
v_mfma_f32_16x16x32_bf16 v[48:51], v[224:227], v[180:183], v[48:51]
v_mfma_f32_16x16x32_bf16 v[52:55], v[224:227], v[184:187], v[52:55]
v_mfma_f32_16x16x32_bf16 v[56:59], v[224:227], v[188:191], v[56:59]
v_mfma_f32_16x16x32_bf16 v[60:63], v[224:227], v[192:195], v[60:63]
s_waitcnt lgkmcnt(0)
v_mfma_f32_16x16x32_bf16 v[0:3], v[220:223], v[136:139], v[0:3]
ds_read_b64_tr_b16 v[224:225], v230 offset:12288
ds_read_b64_tr_b16 v[226:227], v230 offset:12544
v_mfma_f32_16x16x32_bf16 v[4:7], v[220:223], v[140:143], v[4:7]
ds_read_b128 v[212:215], v229 offset:640
ds_read_b128 v[216:219], v229 offset:768
v_mfma_f32_16x16x32_bf16 v[8:11], v[220:223], v[144:147], v[8:11]
v_mfma_f32_16x16x32_bf16 v[12:15], v[220:223], v[148:151], v[12:15]
v_mfma_f32_16x16x32_bf16 v[16:19], v[220:223], v[152:155], v[16:19]
ds_write_b128 v246, v[72:75] offset:2048
v_mfma_f32_16x16x32_bf16 v[20:23], v[220:223], v[156:159], v[20:23]
v_mfma_f32_16x16x32_bf16 v[24:27], v[220:223], v[160:163], v[24:27]
v_mfma_f32_16x16x32_bf16 v[28:31], v[220:223], v[164:167], v[28:31]
v_mfma_f32_16x16x32_bf16 v[32:35], v[220:223], v[168:171], v[32:35]
v_mfma_f32_16x16x32_bf16 v[36:39], v[220:223], v[172:175], v[36:39]
v_mfma_f32_16x16x32_bf16 v[40:43], v[220:223], v[176:179], v[40:43]
ds_write_b128 v246, v[76:79] offset:3072
v_mfma_f32_16x16x32_bf16 v[44:47], v[220:223], v[180:183], v[44:47]
v_mfma_f32_16x16x32_bf16 v[48:51], v[220:223], v[184:187], v[48:51]
v_mfma_f32_16x16x32_bf16 v[52:55], v[220:223], v[188:191], v[52:55]
v_mfma_f32_16x16x32_bf16 v[56:59], v[220:223], v[192:195], v[56:59]
v_mfma_f32_16x16x32_bf16 v[60:63], v[220:223], v[196:199], v[60:63]
s_waitcnt lgkmcnt(0)
s_barrier
v_mfma_f32_16x16x32_bf16 v[0:3], v[224:227], v[140:143], v[0:3]
ds_read_b64_tr_b16 v[220:221], v230 offset:16384
ds_read_b64_tr_b16 v[222:223], v230 offset:16640
v_mfma_f32_16x16x32_bf16 v[4:7], v[224:227], v[144:147], v[4:7]
ds_read_b128 v[128:131], v228 offset:34816
ds_read_b128 v[132:135], v228 offset:34944
v_mfma_f32_16x16x32_bf16 v[8:11], v[224:227], v[148:151], v[8:11]
ds_read_b128 v[136:139], v228 offset:35072
v_mfma_f32_16x16x32_bf16 v[12:15], v[224:227], v[152:155], v[12:15]
v_mfma_f32_16x16x32_bf16 v[16:19], v[224:227], v[156:159], v[16:19]
v_mfma_f32_16x16x32_bf16 v[20:23], v[224:227], v[160:163], v[20:23]
v_mfma_f32_16x16x32_bf16 v[24:27], v[224:227], v[164:167], v[24:27]
v_mfma_f32_16x16x32_bf16 v[28:31], v[224:227], v[168:171], v[28:31]
v_mfma_f32_16x16x32_bf16 v[32:35], v[224:227], v[172:175], v[32:35]
v_mfma_f32_16x16x32_bf16 v[36:39], v[224:227], v[176:179], v[36:39]
v_mfma_f32_16x16x32_bf16 v[40:43], v[224:227], v[180:183], v[40:43]
v_mfma_f32_16x16x32_bf16 v[44:47], v[224:227], v[184:187], v[44:47]
v_mfma_f32_16x16x32_bf16 v[48:51], v[224:227], v[188:191], v[48:51]
v_mfma_f32_16x16x32_bf16 v[52:55], v[224:227], v[192:195], v[52:55]
v_mfma_f32_16x16x32_bf16 v[56:59], v[224:227], v[196:199], v[56:59]
v_mfma_f32_16x16x32_bf16 v[60:63], v[224:227], v[200:203], v[60:63]
s_waitcnt lgkmcnt(0)
v_mfma_f32_16x16x32_bf16 v[0:3], v[220:223], v[144:147], v[0:3]
ds_read_b64_tr_b16 v[224:225], v230 offset:20480
ds_read_b64_tr_b16 v[226:227], v230 offset:20736
v_mfma_f32_16x16x32_bf16 v[4:7], v[220:223], v[148:151], v[4:7]
ds_read_b128 v[140:143], v228 offset:35200
v_mfma_f32_16x16x32_bf16 v[8:11], v[220:223], v[152:155], v[8:11]
v_mfma_f32_16x16x32_bf16 v[12:15], v[220:223], v[156:159], v[12:15]
v_mfma_f32_16x16x32_bf16 v[16:19], v[220:223], v[160:163], v[16:19]
ds_read_b128 v[64:67], v247 offset:0
v_mfma_f32_16x16x32_bf16 v[20:23], v[220:223], v[164:167], v[20:23]
v_mfma_f32_16x16x32_bf16 v[24:27], v[220:223], v[168:171], v[24:27]
v_mfma_f32_16x16x32_bf16 v[28:31], v[220:223], v[172:175], v[28:31]
v_mfma_f32_16x16x32_bf16 v[32:35], v[220:223], v[176:179], v[32:35]
v_mfma_f32_16x16x32_bf16 v[36:39], v[220:223], v[180:183], v[36:39]
v_mfma_f32_16x16x32_bf16 v[40:43], v[220:223], v[184:187], v[40:43]
ds_read_b128 v[68:71], v247 offset:1024
v_mfma_f32_16x16x32_bf16 v[44:47], v[220:223], v[188:191], v[44:47]
v_mfma_f32_16x16x32_bf16 v[48:51], v[220:223], v[192:195], v[48:51]
v_mfma_f32_16x16x32_bf16 v[52:55], v[220:223], v[196:199], v[52:55]
v_mfma_f32_16x16x32_bf16 v[56:59], v[220:223], v[200:203], v[56:59]
v_mfma_f32_16x16x32_bf16 v[60:63], v[220:223], v[204:207], v[60:63]
s_waitcnt lgkmcnt(0)
v_mfma_f32_16x16x32_bf16 v[0:3], v[224:227], v[148:151], v[0:3]
ds_read_b64_tr_b16 v[220:221], v230 offset:24576
ds_read_b64_tr_b16 v[222:223], v230 offset:24832
v_mfma_f32_16x16x32_bf16 v[4:7], v[224:227], v[152:155], v[4:7]
ds_read_b128 v[144:147], v228 offset:35328
v_mfma_f32_16x16x32_bf16 v[8:11], v[224:227], v[156:159], v[8:11]
v_mfma_f32_16x16x32_bf16 v[12:15], v[224:227], v[160:163], v[12:15]
v_mfma_f32_16x16x32_bf16 v[16:19], v[224:227], v[164:167], v[16:19]
ds_read_b128 v[72:75], v247 offset:2048
v_mfma_f32_16x16x32_bf16 v[20:23], v[224:227], v[168:171], v[20:23]
v_mfma_f32_16x16x32_bf16 v[24:27], v[224:227], v[172:175], v[24:27]
v_mfma_f32_16x16x32_bf16 v[28:31], v[224:227], v[176:179], v[28:31]
v_mfma_f32_16x16x32_bf16 v[32:35], v[224:227], v[180:183], v[32:35]
v_mfma_f32_16x16x32_bf16 v[36:39], v[224:227], v[184:187], v[36:39]
v_mfma_f32_16x16x32_bf16 v[40:43], v[224:227], v[188:191], v[40:43]
ds_read_b128 v[76:79], v247 offset:3072
v_mfma_f32_16x16x32_bf16 v[44:47], v[224:227], v[192:195], v[44:47]
v_mfma_f32_16x16x32_bf16 v[48:51], v[224:227], v[196:199], v[48:51]
v_mfma_f32_16x16x32_bf16 v[52:55], v[224:227], v[200:203], v[52:55]
v_mfma_f32_16x16x32_bf16 v[56:59], v[224:227], v[204:207], v[56:59]
v_mfma_f32_16x16x32_bf16 v[60:63], v[224:227], v[208:211], v[60:63]
s_waitcnt lgkmcnt(0)
v_mfma_f32_16x16x32_bf16 v[0:3], v[220:223], v[152:155], v[0:3]
ds_read_b64_tr_b16 v[224:225], v230 offset:28672
ds_read_b64_tr_b16 v[226:227], v230 offset:28928
v_mfma_f32_16x16x32_bf16 v[4:7], v[220:223], v[156:159], v[4:7]
ds_read_b128 v[148:151], v228 offset:35456
v_mfma_f32_16x16x32_bf16 v[8:11], v[220:223], v[160:163], v[8:11]
v_mfma_f32_16x16x32_bf16 v[12:15], v[220:223], v[164:167], v[12:15]
v_mfma_f32_16x16x32_bf16 v[16:19], v[220:223], v[168:171], v[16:19]
v_mfma_f32_16x16x32_bf16 v[20:23], v[220:223], v[172:175], v[20:23]
v_mfma_f32_16x16x32_bf16 v[24:27], v[220:223], v[176:179], v[24:27]
v_mfma_f32_16x16x32_bf16 v[28:31], v[220:223], v[180:183], v[28:31]
v_mfma_f32_16x16x32_bf16 v[32:35], v[220:223], v[184:187], v[32:35]
v_mfma_f32_16x16x32_bf16 v[36:39], v[220:223], v[188:191], v[36:39]
v_mfma_f32_16x16x32_bf16 v[40:43], v[220:223], v[192:195], v[40:43]
v_mfma_f32_16x16x32_bf16 v[44:47], v[220:223], v[196:199], v[44:47]
v_mfma_f32_16x16x32_bf16 v[48:51], v[220:223], v[200:203], v[48:51]
v_mfma_f32_16x16x32_bf16 v[52:55], v[220:223], v[204:207], v[52:55]
v_mfma_f32_16x16x32_bf16 v[56:59], v[220:223], v[208:211], v[56:59]
v_mfma_f32_16x16x32_bf16 v[60:63], v[220:223], v[212:215], v[60:63]
s_waitcnt lgkmcnt(0)
s_barrier
v_mfma_f32_16x16x32_bf16 v[0:3], v[224:227], v[156:159], v[0:3]
ds_read_b64_tr_b16 v[220:221], v230 offset:32768
ds_read_b64_tr_b16 v[222:223], v230 offset:33024
v_mfma_f32_16x16x32_bf16 v[4:7], v[224:227], v[160:163], v[4:7]
ds_read_b128 v[152:155], v228 offset:35584
ds_read_b128 v[156:159], v228 offset:35712
v_mfma_f32_16x16x32_bf16 v[8:11], v[224:227], v[164:167], v[8:11]
ds_read_b128 v[160:163], v228 offset:35840
ds_read_b128 v[164:167], v228 offset:35968
v_mfma_f32_16x16x32_bf16 v[12:15], v[224:227], v[168:171], v[12:15]
ds_read_b128 v[168:171], v228 offset:36096
v_mfma_f32_16x16x32_bf16 v[16:19], v[224:227], v[172:175], v[16:19]
ds_read_b128 v[172:175], v228 offset:36224
v_mfma_f32_16x16x32_bf16 v[20:23], v[224:227], v[176:179], v[20:23]
ds_read_b128 v[176:179], v228 offset:36352
v_mfma_f32_16x16x32_bf16 v[24:27], v[224:227], v[180:183], v[24:27]
ds_read_b128 v[180:183], v228 offset:36480
v_mfma_f32_16x16x32_bf16 v[28:31], v[224:227], v[184:187], v[28:31]
ds_read_b128 v[184:187], v228 offset:36608
v_mfma_f32_16x16x32_bf16 v[32:35], v[224:227], v[188:191], v[32:35]
ds_read_b128 v[188:191], v228 offset:36736
v_mfma_f32_16x16x32_bf16 v[36:39], v[224:227], v[192:195], v[36:39]
v_mfma_f32_16x16x32_bf16 v[40:43], v[224:227], v[196:199], v[40:43]
v_mfma_f32_16x16x32_bf16 v[44:47], v[224:227], v[200:203], v[44:47]
v_mfma_f32_16x16x32_bf16 v[48:51], v[224:227], v[204:207], v[48:51]
v_mfma_f32_16x16x32_bf16 v[52:55], v[224:227], v[208:211], v[52:55]
v_mfma_f32_16x16x32_bf16 v[56:59], v[224:227], v[212:215], v[56:59]
v_mfma_f32_16x16x32_bf16 v[60:63], v[224:227], v[216:219], v[60:63]
s_waitcnt lgkmcnt(9)
v_mfma_f32_16x16x32_bf16 v[0:3], v[220:223], v[128:131], v[0:3]
ds_read_b64_tr_b16 v[224:225], v230 offset:36864
ds_read_b64_tr_b16 v[226:227], v230 offset:37120
v_mfma_f32_16x16x32_bf16 v[4:7], v[220:223], v[132:135], v[4:7]
ds_read_b128 v[192:195], v229 offset:34816
ds_read_b128 v[196:199], v229 offset:34944
v_mfma_f32_16x16x32_bf16 v[8:11], v[220:223], v[136:139], v[8:11]
ds_read_b128 v[200:203], v229 offset:35072
v_mfma_f32_16x16x32_bf16 v[12:15], v[220:223], v[140:143], v[12:15]
v_mfma_f32_16x16x32_bf16 v[16:19], v[220:223], v[144:147], v[16:19]
v_mfma_f32_16x16x32_bf16 v[20:23], v[220:223], v[148:151], v[20:23]
v_mfma_f32_16x16x32_bf16 v[24:27], v[220:223], v[152:155], v[24:27]
s_waitcnt lgkmcnt(5)
v_mfma_f32_16x16x32_bf16 v[28:31], v[220:223], v[156:159], v[28:31]
v_mfma_f32_16x16x32_bf16 v[32:35], v[220:223], v[160:163], v[32:35]
v_mfma_f32_16x16x32_bf16 v[36:39], v[220:223], v[164:167], v[36:39]
v_mfma_f32_16x16x32_bf16 v[40:43], v[220:223], v[168:171], v[40:43]
v_mfma_f32_16x16x32_bf16 v[44:47], v[220:223], v[172:175], v[44:47]
v_mfma_f32_16x16x32_bf16 v[48:51], v[220:223], v[176:179], v[48:51]
v_mfma_f32_16x16x32_bf16 v[52:55], v[220:223], v[180:183], v[52:55]
v_mfma_f32_16x16x32_bf16 v[56:59], v[220:223], v[184:187], v[56:59]
v_mfma_f32_16x16x32_bf16 v[60:63], v[220:223], v[188:191], v[60:63]
s_waitcnt lgkmcnt(0)
v_mfma_f32_16x16x32_bf16 v[0:3], v[224:227], v[132:135], v[0:3]
ds_read_b64_tr_b16 v[220:221], v230 offset:40960
ds_read_b64_tr_b16 v[222:223], v230 offset:41216
v_mfma_f32_16x16x32_bf16 v[4:7], v[224:227], v[136:139], v[4:7]
ds_read_b128 v[204:207], v229 offset:35200
ds_read_b128 v[208:211], v229 offset:35328
v_mfma_f32_16x16x32_bf16 v[8:11], v[224:227], v[140:143], v[8:11]
v_mfma_f32_16x16x32_bf16 v[12:15], v[224:227], v[144:147], v[12:15]
v_mfma_f32_16x16x32_bf16 v[16:19], v[224:227], v[148:151], v[16:19]
ds_write_b128 v246, v[80:83] offset:0
v_mfma_f32_16x16x32_bf16 v[20:23], v[224:227], v[152:155], v[20:23]
v_mfma_f32_16x16x32_bf16 v[24:27], v[224:227], v[156:159], v[24:27]
v_mfma_f32_16x16x32_bf16 v[28:31], v[224:227], v[160:163], v[28:31]
v_mfma_f32_16x16x32_bf16 v[32:35], v[224:227], v[164:167], v[32:35]
v_mfma_f32_16x16x32_bf16 v[36:39], v[224:227], v[168:171], v[36:39]
v_mfma_f32_16x16x32_bf16 v[40:43], v[224:227], v[172:175], v[40:43]
ds_write_b128 v246, v[84:87] offset:1024
v_mfma_f32_16x16x32_bf16 v[44:47], v[224:227], v[176:179], v[44:47]
v_mfma_f32_16x16x32_bf16 v[48:51], v[224:227], v[180:183], v[48:51]
v_mfma_f32_16x16x32_bf16 v[52:55], v[224:227], v[184:187], v[52:55]
v_mfma_f32_16x16x32_bf16 v[56:59], v[224:227], v[188:191], v[56:59]
v_mfma_f32_16x16x32_bf16 v[60:63], v[224:227], v[192:195], v[60:63]
s_waitcnt lgkmcnt(0)
v_mfma_f32_16x16x32_bf16 v[0:3], v[220:223], v[136:139], v[0:3]
ds_read_b64_tr_b16 v[224:225], v230 offset:45056
ds_read_b64_tr_b16 v[226:227], v230 offset:45312
v_mfma_f32_16x16x32_bf16 v[4:7], v[220:223], v[140:143], v[4:7]
ds_read_b128 v[212:215], v229 offset:35456
ds_read_b128 v[216:219], v229 offset:35584
v_mfma_f32_16x16x32_bf16 v[8:11], v[220:223], v[144:147], v[8:11]
v_mfma_f32_16x16x32_bf16 v[12:15], v[220:223], v[148:151], v[12:15]
v_mfma_f32_16x16x32_bf16 v[16:19], v[220:223], v[152:155], v[16:19]
ds_write_b128 v246, v[88:91] offset:2048
v_mfma_f32_16x16x32_bf16 v[20:23], v[220:223], v[156:159], v[20:23]
v_mfma_f32_16x16x32_bf16 v[24:27], v[220:223], v[160:163], v[24:27]
v_mfma_f32_16x16x32_bf16 v[28:31], v[220:223], v[164:167], v[28:31]
v_mfma_f32_16x16x32_bf16 v[32:35], v[220:223], v[168:171], v[32:35]
v_mfma_f32_16x16x32_bf16 v[36:39], v[220:223], v[172:175], v[36:39]
v_mfma_f32_16x16x32_bf16 v[40:43], v[220:223], v[176:179], v[40:43]
ds_write_b128 v246, v[92:95] offset:3072
v_mfma_f32_16x16x32_bf16 v[44:47], v[220:223], v[180:183], v[44:47]
v_mfma_f32_16x16x32_bf16 v[48:51], v[220:223], v[184:187], v[48:51]
v_mfma_f32_16x16x32_bf16 v[52:55], v[220:223], v[188:191], v[52:55]
v_mfma_f32_16x16x32_bf16 v[56:59], v[220:223], v[192:195], v[56:59]
v_mfma_f32_16x16x32_bf16 v[60:63], v[220:223], v[196:199], v[60:63]
s_waitcnt lgkmcnt(0)
s_barrier
v_mfma_f32_16x16x32_bf16 v[0:3], v[224:227], v[140:143], v[0:3]
ds_read_b64_tr_b16 v[220:221], v230 offset:49152
ds_read_b64_tr_b16 v[222:223], v230 offset:49408
v_mfma_f32_16x16x32_bf16 v[4:7], v[224:227], v[144:147], v[4:7]
ds_read_b128 v[128:131], v228 offset:0
ds_read_b128 v[132:135], v228 offset:128
v_mfma_f32_16x16x32_bf16 v[8:11], v[224:227], v[148:151], v[8:11]
ds_read_b128 v[136:139], v228 offset:256
v_mfma_f32_16x16x32_bf16 v[12:15], v[224:227], v[152:155], v[12:15]
v_mfma_f32_16x16x32_bf16 v[16:19], v[224:227], v[156:159], v[16:19]
v_mfma_f32_16x16x32_bf16 v[20:23], v[224:227], v[160:163], v[20:23]
v_mfma_f32_16x16x32_bf16 v[24:27], v[224:227], v[164:167], v[24:27]
v_mfma_f32_16x16x32_bf16 v[28:31], v[224:227], v[168:171], v[28:31]
v_mfma_f32_16x16x32_bf16 v[32:35], v[224:227], v[172:175], v[32:35]
v_mfma_f32_16x16x32_bf16 v[36:39], v[224:227], v[176:179], v[36:39]
v_mfma_f32_16x16x32_bf16 v[40:43], v[224:227], v[180:183], v[40:43]
v_mfma_f32_16x16x32_bf16 v[44:47], v[224:227], v[184:187], v[44:47]
v_mfma_f32_16x16x32_bf16 v[48:51], v[224:227], v[188:191], v[48:51]
v_mfma_f32_16x16x32_bf16 v[52:55], v[224:227], v[192:195], v[52:55]
v_mfma_f32_16x16x32_bf16 v[56:59], v[224:227], v[196:199], v[56:59]
v_mfma_f32_16x16x32_bf16 v[60:63], v[224:227], v[200:203], v[60:63]
s_waitcnt lgkmcnt(0)
v_mfma_f32_16x16x32_bf16 v[0:3], v[220:223], v[144:147], v[0:3]
ds_read_b64_tr_b16 v[224:225], v230 offset:53248
ds_read_b64_tr_b16 v[226:227], v230 offset:53504
v_mfma_f32_16x16x32_bf16 v[4:7], v[220:223], v[148:151], v[4:7]
ds_read_b128 v[140:143], v228 offset:384
v_mfma_f32_16x16x32_bf16 v[8:11], v[220:223], v[152:155], v[8:11]
v_mfma_f32_16x16x32_bf16 v[12:15], v[220:223], v[156:159], v[12:15]
v_mfma_f32_16x16x32_bf16 v[16:19], v[220:223], v[160:163], v[16:19]
ds_read_b128 v[80:83], v247 offset:0
v_mfma_f32_16x16x32_bf16 v[20:23], v[220:223], v[164:167], v[20:23]
v_mfma_f32_16x16x32_bf16 v[24:27], v[220:223], v[168:171], v[24:27]
v_mfma_f32_16x16x32_bf16 v[28:31], v[220:223], v[172:175], v[28:31]
v_mfma_f32_16x16x32_bf16 v[32:35], v[220:223], v[176:179], v[32:35]
v_mfma_f32_16x16x32_bf16 v[36:39], v[220:223], v[180:183], v[36:39]
v_mfma_f32_16x16x32_bf16 v[40:43], v[220:223], v[184:187], v[40:43]
ds_read_b128 v[84:87], v247 offset:1024
v_mfma_f32_16x16x32_bf16 v[44:47], v[220:223], v[188:191], v[44:47]
v_mfma_f32_16x16x32_bf16 v[48:51], v[220:223], v[192:195], v[48:51]
v_mfma_f32_16x16x32_bf16 v[52:55], v[220:223], v[196:199], v[52:55]
v_mfma_f32_16x16x32_bf16 v[56:59], v[220:223], v[200:203], v[56:59]
v_mfma_f32_16x16x32_bf16 v[60:63], v[220:223], v[204:207], v[60:63]
s_waitcnt lgkmcnt(0)
v_mfma_f32_16x16x32_bf16 v[0:3], v[224:227], v[148:151], v[0:3]
ds_read_b64_tr_b16 v[248:249], v230 offset:57344
ds_read_b64_tr_b16 v[250:251], v230 offset:57600
v_mfma_f32_16x16x32_bf16 v[4:7], v[224:227], v[152:155], v[4:7]
ds_read_b128 v[144:147], v228 offset:512
v_mfma_f32_16x16x32_bf16 v[8:11], v[224:227], v[156:159], v[8:11]
v_mfma_f32_16x16x32_bf16 v[12:15], v[224:227], v[160:163], v[12:15]
v_mfma_f32_16x16x32_bf16 v[16:19], v[224:227], v[164:167], v[16:19]
ds_read_b128 v[88:91], v247 offset:2048
v_mfma_f32_16x16x32_bf16 v[20:23], v[224:227], v[168:171], v[20:23]
v_mfma_f32_16x16x32_bf16 v[24:27], v[224:227], v[172:175], v[24:27]
v_mfma_f32_16x16x32_bf16 v[28:31], v[224:227], v[176:179], v[28:31]
v_mfma_f32_16x16x32_bf16 v[32:35], v[224:227], v[180:183], v[32:35]
v_mfma_f32_16x16x32_bf16 v[36:39], v[224:227], v[184:187], v[36:39]
v_mfma_f32_16x16x32_bf16 v[40:43], v[224:227], v[188:191], v[40:43]
ds_read_b128 v[92:95], v247 offset:3072
v_mfma_f32_16x16x32_bf16 v[44:47], v[224:227], v[192:195], v[44:47]
v_mfma_f32_16x16x32_bf16 v[48:51], v[224:227], v[196:199], v[48:51]
v_mfma_f32_16x16x32_bf16 v[52:55], v[224:227], v[200:203], v[52:55]
v_mfma_f32_16x16x32_bf16 v[56:59], v[224:227], v[204:207], v[56:59]
v_mfma_f32_16x16x32_bf16 v[60:63], v[224:227], v[208:211], v[60:63]
s_waitcnt lgkmcnt(0)
v_mfma_f32_16x16x32_bf16 v[0:3], v[248:251], v[152:155], v[0:3]
ds_read_b64_tr_b16 v[224:225], v230 offset:61440
ds_read_b64_tr_b16 v[226:227], v230 offset:61696
v_mfma_f32_16x16x32_bf16 v[4:7], v[248:251], v[156:159], v[4:7]
ds_read_b128 v[148:151], v228 offset:640
v_mfma_f32_16x16x32_bf16 v[8:11], v[248:251], v[160:163], v[8:11]
v_mfma_f32_16x16x32_bf16 v[12:15], v[248:251], v[164:167], v[12:15]
v_mfma_f32_16x16x32_bf16 v[16:19], v[248:251], v[168:171], v[16:19]
v_mfma_f32_16x16x32_bf16 v[20:23], v[248:251], v[172:175], v[20:23]
v_mfma_f32_16x16x32_bf16 v[24:27], v[248:251], v[176:179], v[24:27]
v_mfma_f32_16x16x32_bf16 v[28:31], v[248:251], v[180:183], v[28:31]
v_mfma_f32_16x16x32_bf16 v[32:35], v[248:251], v[184:187], v[32:35]
v_mfma_f32_16x16x32_bf16 v[36:39], v[248:251], v[188:191], v[36:39]
v_mfma_f32_16x16x32_bf16 v[40:43], v[248:251], v[192:195], v[40:43]
v_mfma_f32_16x16x32_bf16 v[44:47], v[248:251], v[196:199], v[44:47]
v_mfma_f32_16x16x32_bf16 v[48:51], v[248:251], v[200:203], v[48:51]
v_mfma_f32_16x16x32_bf16 v[52:55], v[248:251], v[204:207], v[52:55]
v_mfma_f32_16x16x32_bf16 v[56:59], v[248:251], v[208:211], v[56:59]
v_mfma_f32_16x16x32_bf16 v[60:63], v[248:251], v[212:215], v[60:63]
s_waitcnt lgkmcnt(0)
s_barrier
v_mfma_f32_16x16x32_bf16 v[0:3], v[224:227], v[156:159], v[0:3]
ds_read_b64_tr_b16 v[220:221], v230 offset:0
ds_read_b64_tr_b16 v[222:223], v230 offset:256
v_mfma_f32_16x16x32_bf16 v[4:7], v[224:227], v[160:163], v[4:7]
ds_read_b128 v[152:155], v228 offset:768
ds_read_b128 v[156:159], v228 offset:896
v_mfma_f32_16x16x32_bf16 v[8:11], v[224:227], v[164:167], v[8:11]
ds_read_b128 v[160:163], v228 offset:1024
ds_read_b128 v[164:167], v228 offset:1152
v_mfma_f32_16x16x32_bf16 v[12:15], v[224:227], v[168:171], v[12:15]
ds_read_b128 v[168:171], v228 offset:1280
v_mfma_f32_16x16x32_bf16 v[16:19], v[224:227], v[172:175], v[16:19]
ds_read_b128 v[172:175], v228 offset:1408
v_mfma_f32_16x16x32_bf16 v[20:23], v[224:227], v[176:179], v[20:23]
ds_read_b128 v[176:179], v228 offset:1536
v_mfma_f32_16x16x32_bf16 v[24:27], v[224:227], v[180:183], v[24:27]
ds_read_b128 v[180:183], v228 offset:1664
v_mfma_f32_16x16x32_bf16 v[28:31], v[224:227], v[184:187], v[28:31]
ds_read_b128 v[184:187], v228 offset:1792
v_mfma_f32_16x16x32_bf16 v[32:35], v[224:227], v[188:191], v[32:35]
ds_read_b128 v[188:191], v228 offset:1920
v_mfma_f32_16x16x32_bf16 v[36:39], v[224:227], v[192:195], v[36:39]
v_mfma_f32_16x16x32_bf16 v[40:43], v[224:227], v[196:199], v[40:43]
v_mfma_f32_16x16x32_bf16 v[44:47], v[224:227], v[200:203], v[44:47]
v_mfma_f32_16x16x32_bf16 v[48:51], v[224:227], v[204:207], v[48:51]
v_mfma_f32_16x16x32_bf16 v[52:55], v[224:227], v[208:211], v[52:55]
s_add_u32 s43, s43, 1
v_mfma_f32_16x16x32_bf16 v[56:59], v[224:227], v[212:215], v[56:59]
v_mfma_f32_16x16x32_bf16 v[60:63], v[224:227], v[216:219], v[60:63]
.p2align 4
L_loopQ1:
s_waitcnt lgkmcnt(9)
v_mfma_f32_16x16x32_bf16 v[0:3], v[220:223], v[128:131], v[0:3]
ds_read_b64_tr_b16 v[224:225], v230 offset:4096
ds_read_b64_tr_b16 v[226:227], v230 offset:4352
v_mfma_f32_16x16x32_bf16 v[4:7], v[220:223], v[132:135], v[4:7]
ds_read_b128 v[192:195], v229 offset:0
ds_read_b128 v[196:199], v229 offset:128
v_mfma_f32_16x16x32_bf16 v[8:11], v[220:223], v[136:139], v[8:11]
ds_read_b128 v[200:203], v229 offset:256
v_mfma_f32_16x16x32_bf16 v[12:15], v[220:223], v[140:143], v[12:15]
v_add_f32 v64, v64, v96
v_mfma_f32_16x16x32_bf16 v[16:19], v[220:223], v[144:147], v[16:19]
v_add_f32 v65, v65, v97
v_mfma_f32_16x16x32_bf16 v[20:23], v[220:223], v[148:151], v[20:23]
v_add_f32 v66, v66, v98
v_mfma_f32_16x16x32_bf16 v[24:27], v[220:223], v[152:155], v[24:27]
s_waitcnt lgkmcnt(5)
v_mfma_f32_16x16x32_bf16 v[28:31], v[220:223], v[156:159], v[28:31]
v_add_f32 v67, v67, v99
v_mfma_f32_16x16x32_bf16 v[32:35], v[220:223], v[160:163], v[32:35]
v_add_f32 v68, v68, v100
v_mfma_f32_16x16x32_bf16 v[36:39], v[220:223], v[164:167], v[36:39]
v_add_f32 v69, v69, v101
v_mfma_f32_16x16x32_bf16 v[40:43], v[220:223], v[168:171], v[40:43]
v_add_f32 v70, v70, v102
v_mfma_f32_16x16x32_bf16 v[44:47], v[220:223], v[172:175], v[44:47]
v_add_f32 v71, v71, v103
v_mfma_f32_16x16x32_bf16 v[48:51], v[220:223], v[176:179], v[48:51]
v_add_f32 v72, v72, v104
v_mfma_f32_16x16x32_bf16 v[52:55], v[220:223], v[180:183], v[52:55]
v_add_f32 v73, v73, v105
v_mfma_f32_16x16x32_bf16 v[56:59], v[220:223], v[184:187], v[56:59]
v_add_f32 v74, v74, v106
v_mfma_f32_16x16x32_bf16 v[60:63], v[220:223], v[188:191], v[60:63]
v_add_f32 v75, v75, v107
s_waitcnt lgkmcnt(0)
v_mfma_f32_16x16x32_bf16 v[0:3], v[224:227], v[132:135], v[0:3]
ds_read_b64_tr_b16 v[220:221], v230 offset:8192
ds_read_b64_tr_b16 v[222:223], v230 offset:8448
v_mfma_f32_16x16x32_bf16 v[4:7], v[224:227], v[136:139], v[4:7]
ds_read_b128 v[204:207], v229 offset:384
ds_read_b128 v[208:211], v229 offset:512
v_mfma_f32_16x16x32_bf16 v[8:11], v[224:227], v[140:143], v[8:11]
v_add_f32 v76, v76, v108
v_mfma_f32_16x16x32_bf16 v[12:15], v[224:227], v[144:147], v[12:15]
v_add_f32 v77, v77, v109
v_mfma_f32_16x16x32_bf16 v[16:19], v[224:227], v[148:151], v[16:19]
v_add_f32 v78, v78, v110
v_mfma_f32_16x16x32_bf16 v[20:23], v[224:227], v[152:155], v[20:23]
v_add_f32 v79, v79, v111
v_mfma_f32_16x16x32_bf16 v[24:27], v[224:227], v[156:159], v[24:27]
v_add_f32 v80, v80, v112
v_mfma_f32_16x16x32_bf16 v[28:31], v[224:227], v[160:163], v[28:31]
v_add_f32 v81, v81, v113
v_mfma_f32_16x16x32_bf16 v[32:35], v[224:227], v[164:167], v[32:35]
v_add_f32 v82, v82, v114
v_mfma_f32_16x16x32_bf16 v[36:39], v[224:227], v[168:171], v[36:39]
v_add_f32 v83, v83, v115
v_mfma_f32_16x16x32_bf16 v[40:43], v[224:227], v[172:175], v[40:43]
v_add_f32 v84, v84, v116
v_mfma_f32_16x16x32_bf16 v[44:47], v[224:227], v[176:179], v[44:47]
v_add_f32 v85, v85, v117
v_mfma_f32_16x16x32_bf16 v[48:51], v[224:227], v[180:183], v[48:51]
v_add_f32 v86, v86, v118
v_mfma_f32_16x16x32_bf16 v[52:55], v[224:227], v[184:187], v[52:55]
v_add_f32 v87, v87, v119
v_mfma_f32_16x16x32_bf16 v[56:59], v[224:227], v[188:191], v[56:59]
v_add_f32 v88, v88, v120
v_mfma_f32_16x16x32_bf16 v[60:63], v[224:227], v[192:195], v[60:63]
v_add_f32 v89, v89, v121
s_waitcnt lgkmcnt(0)
v_mfma_f32_16x16x32_bf16 v[0:3], v[220:223], v[136:139], v[0:3]
ds_read_b64_tr_b16 v[224:225], v230 offset:12288
ds_read_b64_tr_b16 v[226:227], v230 offset:12544
v_mfma_f32_16x16x32_bf16 v[4:7], v[220:223], v[140:143], v[4:7]
ds_read_b128 v[212:215], v229 offset:640
ds_read_b128 v[216:219], v229 offset:768
v_mfma_f32_16x16x32_bf16 v[8:11], v[220:223], v[144:147], v[8:11]
v_add_f32 v90, v90, v122
v_mfma_f32_16x16x32_bf16 v[12:15], v[220:223], v[148:151], v[12:15]
v_add_f32 v91, v91, v123
v_mfma_f32_16x16x32_bf16 v[16:19], v[220:223], v[152:155], v[16:19]
v_add_f32 v92, v92, v124
v_mfma_f32_16x16x32_bf16 v[20:23], v[220:223], v[156:159], v[20:23]
v_add_f32 v93, v93, v125
v_mfma_f32_16x16x32_bf16 v[24:27], v[220:223], v[160:163], v[24:27]
v_add_f32 v94, v94, v126
v_mfma_f32_16x16x32_bf16 v[28:31], v[220:223], v[164:167], v[28:31]
v_add_f32 v95, v95, v127
v_mfma_f32_16x16x32_bf16 v[32:35], v[220:223], v[168:171], v[32:35]
v_mov_b32_dpp v96, v64 row_newbcast:0 row_mask:0xf bank_mask:0xf
v_mfma_f32_16x16x32_bf16 v[36:39], v[220:223], v[172:175], v[36:39]
v_mov_b32_dpp v97, v65 row_newbcast:0 row_mask:0xf bank_mask:0xf
v_mfma_f32_16x16x32_bf16 v[40:43], v[220:223], v[176:179], v[40:43]
v_mov_b32_dpp v98, v66 row_newbcast:0 row_mask:0xf bank_mask:0xf
v_mfma_f32_16x16x32_bf16 v[44:47], v[220:223], v[180:183], v[44:47]
v_mov_b32_dpp v99, v67 row_newbcast:0 row_mask:0xf bank_mask:0xf
v_mfma_f32_16x16x32_bf16 v[48:51], v[220:223], v[184:187], v[48:51]
v_sub_f32 v64, v64, v96
v_mfma_f32_16x16x32_bf16 v[52:55], v[220:223], v[188:191], v[52:55]
v_sub_f32 v65, v65, v97
v_mfma_f32_16x16x32_bf16 v[56:59], v[220:223], v[192:195], v[56:59]
v_sub_f32 v66, v66, v98
v_mfma_f32_16x16x32_bf16 v[60:63], v[220:223], v[196:199], v[60:63]
v_sub_f32 v67, v67, v99
s_waitcnt lgkmcnt(0)
s_barrier
v_mfma_f32_16x16x32_bf16 v[0:3], v[224:227], v[140:143], v[0:3]
ds_read_b64_tr_b16 v[220:221], v230 offset:16384
ds_read_b64_tr_b16 v[222:223], v230 offset:16640
v_mfma_f32_16x16x32_bf16 v[4:7], v[224:227], v[144:147], v[4:7]
ds_read_b128 v[128:131], v228 offset:34816
ds_read_b128 v[132:135], v228 offset:34944
v_mfma_f32_16x16x32_bf16 v[8:11], v[224:227], v[148:151], v[8:11]
ds_read_b128 v[136:139], v228 offset:35072
v_mfma_f32_16x16x32_bf16 v[12:15], v[224:227], v[152:155], v[12:15]
v_cndmask_b32 v64, 0, v64, s[56:57]
v_mfma_f32_16x16x32_bf16 v[16:19], v[224:227], v[156:159], v[16:19]
v_cndmask_b32 v65, 0, v65, s[56:57]
v_mfma_f32_16x16x32_bf16 v[20:23], v[224:227], v[160:163], v[20:23]
v_cndmask_b32 v66, 0, v66, s[56:57]
v_mfma_f32_16x16x32_bf16 v[24:27], v[224:227], v[164:167], v[24:27]
v_cndmask_b32 v67, 0, v67, s[56:57]
v_mfma_f32_16x16x32_bf16 v[28:31], v[224:227], v[168:171], v[28:31]
v_mul_f32 v104, v64, v64
v_mfma_f32_16x16x32_bf16 v[32:35], v[224:227], v[172:175], v[32:35]
v_mul_f32 v105, v65, v65
v_mfma_f32_16x16x32_bf16 v[36:39], v[224:227], v[176:179], v[36:39]
v_mul_f32 v106, v66, v66
v_mfma_f32_16x16x32_bf16 v[40:43], v[224:227], v[180:183], v[40:43]
v_mul_f32 v107, v67, v67
v_mfma_f32_16x16x32_bf16 v[44:47], v[224:227], v[184:187], v[44:47]
v_sub_f32 v68, v68, v96
v_mfma_f32_16x16x32_bf16 v[48:51], v[224:227], v[188:191], v[48:51]
v_sub_f32 v69, v69, v97
v_mfma_f32_16x16x32_bf16 v[52:55], v[224:227], v[192:195], v[52:55]
v_sub_f32 v70, v70, v98
v_mfma_f32_16x16x32_bf16 v[56:59], v[224:227], v[196:199], v[56:59]
v_sub_f32 v71, v71, v99
v_mfma_f32_16x16x32_bf16 v[60:63], v[224:227], v[200:203], v[60:63]
v_cndmask_b32 v68, 0, v68, s[58:59]
s_waitcnt lgkmcnt(0)
v_mfma_f32_16x16x32_bf16 v[0:3], v[220:223], v[144:147], v[0:3]
ds_read_b64_tr_b16 v[224:225], v230 offset:20480
ds_read_b64_tr_b16 v[226:227], v230 offset:20736
v_mfma_f32_16x16x32_bf16 v[4:7], v[220:223], v[148:151], v[4:7]
ds_read_b128 v[140:143], v228 offset:35200
v_mfma_f32_16x16x32_bf16 v[8:11], v[220:223], v[152:155], v[8:11]
v_cndmask_b32 v69, 0, v69, s[58:59]
v_mfma_f32_16x16x32_bf16 v[12:15], v[220:223], v[156:159], v[12:15]
v_cndmask_b32 v70, 0, v70, s[58:59]
v_mfma_f32_16x16x32_bf16 v[16:19], v[220:223], v[160:163], v[16:19]
v_cndmask_b32 v71, 0, v71, s[58:59]
v_mfma_f32_16x16x32_bf16 v[20:23], v[220:223], v[164:167], v[20:23]
v_add_f32 v100, v68, v64
v_mfma_f32_16x16x32_bf16 v[24:27], v[220:223], v[168:171], v[24:27]
v_add_f32 v101, v69, v65
v_mfma_f32_16x16x32_bf16 v[28:31], v[220:223], v[172:175], v[28:31]
v_add_f32 v102, v70, v66
v_mfma_f32_16x16x32_bf16 v[32:35], v[220:223], v[176:179], v[32:35]
v_add_f32 v103, v71, v67
v_mfma_f32_16x16x32_bf16 v[36:39], v[220:223], v[180:183], v[36:39]
v_fmac_f32 v104, v68, v68
v_mfma_f32_16x16x32_bf16 v[40:43], v[220:223], v[184:187], v[40:43]
v_fmac_f32 v105, v69, v69
v_mfma_f32_16x16x32_bf16 v[44:47], v[220:223], v[188:191], v[44:47]
v_fmac_f32 v106, v70, v70
v_mfma_f32_16x16x32_bf16 v[48:51], v[220:223], v[192:195], v[48:51]
v_fmac_f32 v107, v71, v71
v_mfma_f32_16x16x32_bf16 v[52:55], v[220:223], v[196:199], v[52:55]
v_sub_f32 v72, v72, v96
v_mfma_f32_16x16x32_bf16 v[56:59], v[220:223], v[200:203], v[56:59]
v_sub_f32 v73, v73, v97
v_mfma_f32_16x16x32_bf16 v[60:63], v[220:223], v[204:207], v[60:63]
v_sub_f32 v74, v74, v98
s_waitcnt lgkmcnt(0)
v_mfma_f32_16x16x32_bf16 v[0:3], v[224:227], v[148:151], v[0:3]
ds_read_b64_tr_b16 v[220:221], v230 offset:24576
ds_read_b64_tr_b16 v[222:223], v230 offset:24832
v_mfma_f32_16x16x32_bf16 v[4:7], v[224:227], v[152:155], v[4:7]
ds_read_b128 v[144:147], v228 offset:35328
v_mfma_f32_16x16x32_bf16 v[8:11], v[224:227], v[156:159], v[8:11]
v_sub_f32 v75, v75, v99
v_mfma_f32_16x16x32_bf16 v[12:15], v[224:227], v[160:163], v[12:15]
v_cndmask_b32 v72, 0, v72, s[60:61]
v_mfma_f32_16x16x32_bf16 v[16:19], v[224:227], v[164:167], v[16:19]
v_cndmask_b32 v73, 0, v73, s[60:61]
v_mfma_f32_16x16x32_bf16 v[20:23], v[224:227], v[168:171], v[20:23]
v_cndmask_b32 v74, 0, v74, s[60:61]
v_mfma_f32_16x16x32_bf16 v[24:27], v[224:227], v[172:175], v[24:27]
v_cndmask_b32 v75, 0, v75, s[60:61]
v_mfma_f32_16x16x32_bf16 v[28:31], v[224:227], v[176:179], v[28:31]
v_add_f32 v100, v72, v100
v_mfma_f32_16x16x32_bf16 v[32:35], v[224:227], v[180:183], v[32:35]
v_add_f32 v101, v73, v101
v_mfma_f32_16x16x32_bf16 v[36:39], v[224:227], v[184:187], v[36:39]
v_add_f32 v102, v74, v102
v_mfma_f32_16x16x32_bf16 v[40:43], v[224:227], v[188:191], v[40:43]
v_add_f32 v103, v75, v103
v_mfma_f32_16x16x32_bf16 v[44:47], v[224:227], v[192:195], v[44:47]
v_fmac_f32 v104, v72, v72
v_mfma_f32_16x16x32_bf16 v[48:51], v[224:227], v[196:199], v[48:51]
v_fmac_f32 v105, v73, v73
v_mfma_f32_16x16x32_bf16 v[52:55], v[224:227], v[200:203], v[52:55]
v_fmac_f32 v106, v74, v74
v_mfma_f32_16x16x32_bf16 v[56:59], v[224:227], v[204:207], v[56:59]
v_fmac_f32 v107, v75, v75
v_mfma_f32_16x16x32_bf16 v[60:63], v[224:227], v[208:211], v[60:63]
v_sub_f32 v76, v76, v96
s_waitcnt lgkmcnt(0)
v_mfma_f32_16x16x32_bf16 v[0:3], v[220:223], v[152:155], v[0:3]
ds_read_b64_tr_b16 v[224:225], v230 offset:28672
ds_read_b64_tr_b16 v[226:227], v230 offset:28928
v_mfma_f32_16x16x32_bf16 v[4:7], v[220:223], v[156:159], v[4:7]
ds_read_b128 v[148:151], v228 offset:35456
v_mfma_f32_16x16x32_bf16 v[8:11], v[220:223], v[160:163], v[8:11]
v_sub_f32 v77, v77, v97
v_mfma_f32_16x16x32_bf16 v[12:15], v[220:223], v[164:167], v[12:15]
v_sub_f32 v78, v78, v98
v_mfma_f32_16x16x32_bf16 v[16:19], v[220:223], v[168:171], v[16:19]
v_sub_f32 v79, v79, v99
v_mfma_f32_16x16x32_bf16 v[20:23], v[220:223], v[172:175], v[20:23]
v_cndmask_b32 v76, 0, v76, s[62:63]
v_mfma_f32_16x16x32_bf16 v[24:27], v[220:223], v[176:179], v[24:27]
v_cndmask_b32 v77, 0, v77, s[62:63]
v_mfma_f32_16x16x32_bf16 v[28:31], v[220:223], v[180:183], v[28:31]
v_cndmask_b32 v78, 0, v78, s[62:63]
v_mfma_f32_16x16x32_bf16 v[32:35], v[220:223], v[184:187], v[32:35]
v_cndmask_b32 v79, 0, v79, s[62:63]
v_mfma_f32_16x16x32_bf16 v[36:39], v[220:223], v[188:191], v[36:39]
v_add_f32 v100, v76, v100
v_mfma_f32_16x16x32_bf16 v[40:43], v[220:223], v[192:195], v[40:43]
v_add_f32 v101, v77, v101
v_mfma_f32_16x16x32_bf16 v[44:47], v[220:223], v[196:199], v[44:47]
v_add_f32 v102, v78, v102
v_mfma_f32_16x16x32_bf16 v[48:51], v[220:223], v[200:203], v[48:51]
v_add_f32 v103, v79, v103
v_mfma_f32_16x16x32_bf16 v[52:55], v[220:223], v[204:207], v[52:55]
v_fmac_f32 v104, v76, v76
v_mfma_f32_16x16x32_bf16 v[56:59], v[220:223], v[208:211], v[56:59]
v_fmac_f32 v105, v77, v77
v_mfma_f32_16x16x32_bf16 v[60:63], v[220:223], v[212:215], v[60:63]
v_fmac_f32 v106, v78, v78
s_waitcnt lgkmcnt(0)
s_barrier
v_mfma_f32_16x16x32_bf16 v[0:3], v[224:227], v[156:159], v[0:3]
ds_read_b64_tr_b16 v[220:221], v230 offset:32768
ds_read_b64_tr_b16 v[222:223], v230 offset:33024
v_mfma_f32_16x16x32_bf16 v[4:7], v[224:227], v[160:163], v[4:7]
ds_read_b128 v[152:155], v228 offset:35584
ds_read_b128 v[156:159], v228 offset:35712
v_mfma_f32_16x16x32_bf16 v[8:11], v[224:227], v[164:167], v[8:11]
ds_read_b128 v[160:163], v228 offset:35840
ds_read_b128 v[164:167], v228 offset:35968
v_mfma_f32_16x16x32_bf16 v[12:15], v[224:227], v[168:171], v[12:15]
ds_read_b128 v[168:171], v228 offset:36096
v_mfma_f32_16x16x32_bf16 v[16:19], v[224:227], v[172:175], v[16:19]
ds_read_b128 v[172:175], v228 offset:36224
v_mfma_f32_16x16x32_bf16 v[20:23], v[224:227], v[176:179], v[20:23]
ds_read_b128 v[176:179], v228 offset:36352
v_mfma_f32_16x16x32_bf16 v[24:27], v[224:227], v[180:183], v[24:27]
ds_read_b128 v[180:183], v228 offset:36480
v_mfma_f32_16x16x32_bf16 v[28:31], v[224:227], v[184:187], v[28:31]
ds_read_b128 v[184:187], v228 offset:36608
v_mfma_f32_16x16x32_bf16 v[32:35], v[224:227], v[188:191], v[32:35]
ds_read_b128 v[188:191], v228 offset:36736
v_mfma_f32_16x16x32_bf16 v[36:39], v[224:227], v[192:195], v[36:39]
v_fmac_f32 v107, v79, v79
v_mfma_f32_16x16x32_bf16 v[40:43], v[224:227], v[196:199], v[40:43]
v_sub_f32 v80, v80, v96
v_mfma_f32_16x16x32_bf16 v[44:47], v[224:227], v[200:203], v[44:47]
v_sub_f32 v81, v81, v97
v_mfma_f32_16x16x32_bf16 v[48:51], v[224:227], v[204:207], v[48:51]
v_sub_f32 v82, v82, v98
v_mfma_f32_16x16x32_bf16 v[52:55], v[224:227], v[208:211], v[52:55]
v_sub_f32 v83, v83, v99
v_mfma_f32_16x16x32_bf16 v[56:59], v[224:227], v[212:215], v[56:59]
v_cndmask_b32 v80, 0, v80, s[64:65]
v_mfma_f32_16x16x32_bf16 v[60:63], v[224:227], v[216:219], v[60:63]
v_cndmask_b32 v81, 0, v81, s[64:65]
s_waitcnt lgkmcnt(9)
v_mfma_f32_16x16x32_bf16 v[0:3], v[220:223], v[128:131], v[0:3]
ds_read_b64_tr_b16 v[224:225], v230 offset:36864
ds_read_b64_tr_b16 v[226:227], v230 offset:37120
v_mfma_f32_16x16x32_bf16 v[4:7], v[220:223], v[132:135], v[4:7]
ds_read_b128 v[192:195], v229 offset:34816
ds_read_b128 v[196:199], v229 offset:34944
v_mfma_f32_16x16x32_bf16 v[8:11], v[220:223], v[136:139], v[8:11]
ds_read_b128 v[200:203], v229 offset:35072
v_mfma_f32_16x16x32_bf16 v[12:15], v[220:223], v[140:143], v[12:15]
v_cndmask_b32 v82, 0, v82, s[64:65]
v_mfma_f32_16x16x32_bf16 v[16:19], v[220:223], v[144:147], v[16:19]
v_cndmask_b32 v83, 0, v83, s[64:65]
v_mfma_f32_16x16x32_bf16 v[20:23], v[220:223], v[148:151], v[20:23]
v_add_f32 v100, v80, v100
v_mfma_f32_16x16x32_bf16 v[24:27], v[220:223], v[152:155], v[24:27]
s_waitcnt lgkmcnt(5)
v_mfma_f32_16x16x32_bf16 v[28:31], v[220:223], v[156:159], v[28:31]
v_add_f32 v101, v81, v101
v_mfma_f32_16x16x32_bf16 v[32:35], v[220:223], v[160:163], v[32:35]
v_add_f32 v102, v82, v102
v_mfma_f32_16x16x32_bf16 v[36:39], v[220:223], v[164:167], v[36:39]
v_add_f32 v103, v83, v103
v_mfma_f32_16x16x32_bf16 v[40:43], v[220:223], v[168:171], v[40:43]
v_fmac_f32 v104, v80, v80
v_mfma_f32_16x16x32_bf16 v[44:47], v[220:223], v[172:175], v[44:47]
v_fmac_f32 v105, v81, v81
v_mfma_f32_16x16x32_bf16 v[48:51], v[220:223], v[176:179], v[48:51]
v_fmac_f32 v106, v82, v82
v_mfma_f32_16x16x32_bf16 v[52:55], v[220:223], v[180:183], v[52:55]
v_fmac_f32 v107, v83, v83
v_mfma_f32_16x16x32_bf16 v[56:59], v[220:223], v[184:187], v[56:59]
v_sub_f32 v84, v84, v96
v_mfma_f32_16x16x32_bf16 v[60:63], v[220:223], v[188:191], v[60:63]
v_sub_f32 v85, v85, v97
s_waitcnt lgkmcnt(0)
v_mfma_f32_16x16x32_bf16 v[0:3], v[224:227], v[132:135], v[0:3]
ds_read_b64_tr_b16 v[220:221], v230 offset:40960
ds_read_b64_tr_b16 v[222:223], v230 offset:41216
v_mfma_f32_16x16x32_bf16 v[4:7], v[224:227], v[136:139], v[4:7]
ds_read_b128 v[204:207], v229 offset:35200
ds_read_b128 v[208:211], v229 offset:35328
v_mfma_f32_16x16x32_bf16 v[8:11], v[224:227], v[140:143], v[8:11]
v_sub_f32 v86, v86, v98
v_mfma_f32_16x16x32_bf16 v[12:15], v[224:227], v[144:147], v[12:15]
v_sub_f32 v87, v87, v99
v_mfma_f32_16x16x32_bf16 v[16:19], v[224:227], v[148:151], v[16:19]
v_cndmask_b32 v84, 0, v84, s[66:67]
v_mfma_f32_16x16x32_bf16 v[20:23], v[224:227], v[152:155], v[20:23]
v_cndmask_b32 v85, 0, v85, s[66:67]
v_mfma_f32_16x16x32_bf16 v[24:27], v[224:227], v[156:159], v[24:27]
v_cndmask_b32 v86, 0, v86, s[66:67]
v_mfma_f32_16x16x32_bf16 v[28:31], v[224:227], v[160:163], v[28:31]
v_cndmask_b32 v87, 0, v87, s[66:67]
v_mfma_f32_16x16x32_bf16 v[32:35], v[224:227], v[164:167], v[32:35]
v_add_f32 v100, v84, v100
v_mfma_f32_16x16x32_bf16 v[36:39], v[224:227], v[168:171], v[36:39]
v_add_f32 v101, v85, v101
v_mfma_f32_16x16x32_bf16 v[40:43], v[224:227], v[172:175], v[40:43]
v_add_f32 v102, v86, v102
v_mfma_f32_16x16x32_bf16 v[44:47], v[224:227], v[176:179], v[44:47]
v_add_f32 v103, v87, v103
v_mfma_f32_16x16x32_bf16 v[48:51], v[224:227], v[180:183], v[48:51]
v_fmac_f32 v104, v84, v84
v_mfma_f32_16x16x32_bf16 v[52:55], v[224:227], v[184:187], v[52:55]
v_fmac_f32 v105, v85, v85
v_mfma_f32_16x16x32_bf16 v[56:59], v[224:227], v[188:191], v[56:59]
v_fmac_f32 v106, v86, v86
v_mfma_f32_16x16x32_bf16 v[60:63], v[224:227], v[192:195], v[60:63]
v_fmac_f32 v107, v87, v87
s_waitcnt lgkmcnt(0)
v_mfma_f32_16x16x32_bf16 v[0:3], v[220:223], v[136:139], v[0:3]
ds_read_b64_tr_b16 v[224:225], v230 offset:45056
ds_read_b64_tr_b16 v[226:227], v230 offset:45312
v_mfma_f32_16x16x32_bf16 v[4:7], v[220:223], v[140:143], v[4:7]
ds_read_b128 v[212:215], v229 offset:35456
ds_read_b128 v[216:219], v229 offset:35584
v_mfma_f32_16x16x32_bf16 v[8:11], v[220:223], v[144:147], v[8:11]
v_sub_f32 v88, v88, v96
v_mfma_f32_16x16x32_bf16 v[12:15], v[220:223], v[148:151], v[12:15]
v_sub_f32 v89, v89, v97
v_mfma_f32_16x16x32_bf16 v[16:19], v[220:223], v[152:155], v[16:19]
v_sub_f32 v90, v90, v98
v_mfma_f32_16x16x32_bf16 v[20:23], v[220:223], v[156:159], v[20:23]
v_sub_f32 v91, v91, v99
v_mfma_f32_16x16x32_bf16 v[24:27], v[220:223], v[160:163], v[24:27]
v_cndmask_b32 v88, 0, v88, s[68:69]
v_mfma_f32_16x16x32_bf16 v[28:31], v[220:223], v[164:167], v[28:31]
v_cndmask_b32 v89, 0, v89, s[68:69]
v_mfma_f32_16x16x32_bf16 v[32:35], v[220:223], v[168:171], v[32:35]
v_cndmask_b32 v90, 0, v90, s[68:69]
v_mfma_f32_16x16x32_bf16 v[36:39], v[220:223], v[172:175], v[36:39]
v_cndmask_b32 v91, 0, v91, s[68:69]
v_mfma_f32_16x16x32_bf16 v[40:43], v[220:223], v[176:179], v[40:43]
v_add_f32 v100, v88, v100
v_mfma_f32_16x16x32_bf16 v[44:47], v[220:223], v[180:183], v[44:47]
v_add_f32 v101, v89, v101
v_mfma_f32_16x16x32_bf16 v[48:51], v[220:223], v[184:187], v[48:51]
v_add_f32 v102, v90, v102
v_mfma_f32_16x16x32_bf16 v[52:55], v[220:223], v[188:191], v[52:55]
v_add_f32 v103, v91, v103
v_mfma_f32_16x16x32_bf16 v[56:59], v[220:223], v[192:195], v[56:59]
v_fmac_f32 v104, v88, v88
v_mfma_f32_16x16x32_bf16 v[60:63], v[220:223], v[196:199], v[60:63]
v_fmac_f32 v105, v89, v89
s_waitcnt lgkmcnt(0)
s_barrier
v_mfma_f32_16x16x32_bf16 v[0:3], v[224:227], v[140:143], v[0:3]
ds_read_b64_tr_b16 v[220:221], v230 offset:49152
ds_read_b64_tr_b16 v[222:223], v230 offset:49408
v_mfma_f32_16x16x32_bf16 v[4:7], v[224:227], v[144:147], v[4:7]
ds_read_b128 v[128:131], v228 offset:0
ds_read_b128 v[132:135], v228 offset:128
v_mfma_f32_16x16x32_bf16 v[8:11], v[224:227], v[148:151], v[8:11]
ds_read_b128 v[136:139], v228 offset:256
v_mfma_f32_16x16x32_bf16 v[12:15], v[224:227], v[152:155], v[12:15]
v_fmac_f32 v106, v90, v90
v_mfma_f32_16x16x32_bf16 v[16:19], v[224:227], v[156:159], v[16:19]
v_fmac_f32 v107, v91, v91
v_mfma_f32_16x16x32_bf16 v[20:23], v[224:227], v[160:163], v[20:23]
v_sub_f32 v92, v92, v96
v_mfma_f32_16x16x32_bf16 v[24:27], v[224:227], v[164:167], v[24:27]
v_sub_f32 v93, v93, v97
v_mfma_f32_16x16x32_bf16 v[28:31], v[224:227], v[168:171], v[28:31]
v_sub_f32 v94, v94, v98
v_mfma_f32_16x16x32_bf16 v[32:35], v[224:227], v[172:175], v[32:35]
v_sub_f32 v95, v95, v99
v_mfma_f32_16x16x32_bf16 v[36:39], v[224:227], v[176:179], v[36:39]
v_cndmask_b32 v92, 0, v92, s[70:71]
v_mfma_f32_16x16x32_bf16 v[40:43], v[224:227], v[180:183], v[40:43]
v_cndmask_b32 v93, 0, v93, s[70:71]
v_mfma_f32_16x16x32_bf16 v[44:47], v[224:227], v[184:187], v[44:47]
v_cndmask_b32 v94, 0, v94, s[70:71]
v_mfma_f32_16x16x32_bf16 v[48:51], v[224:227], v[188:191], v[48:51]
v_cndmask_b32 v95, 0, v95, s[70:71]
v_mfma_f32_16x16x32_bf16 v[52:55], v[224:227], v[192:195], v[52:55]
v_add_f32 v100, v92, v100
v_mfma_f32_16x16x32_bf16 v[56:59], v[224:227], v[196:199], v[56:59]
v_add_f32 v101, v93, v101
v_mfma_f32_16x16x32_bf16 v[60:63], v[224:227], v[200:203], v[60:63]
v_add_f32 v102, v94, v102
s_waitcnt lgkmcnt(0)
v_mfma_f32_16x16x32_bf16 v[0:3], v[220:223], v[144:147], v[0:3]
ds_read_b64_tr_b16 v[224:225], v230 offset:53248
ds_read_b64_tr_b16 v[226:227], v230 offset:53504
v_mfma_f32_16x16x32_bf16 v[4:7], v[220:223], v[148:151], v[4:7]
ds_read_b128 v[140:143], v228 offset:384
v_mfma_f32_16x16x32_bf16 v[8:11], v[220:223], v[152:155], v[8:11]
v_add_f32 v103, v95, v103
v_mfma_f32_16x16x32_bf16 v[12:15], v[220:223], v[156:159], v[12:15]
v_fmac_f32 v104, v92, v92
v_mfma_f32_16x16x32_bf16 v[16:19], v[220:223], v[160:163], v[16:19]
v_fmac_f32 v105, v93, v93
v_mfma_f32_16x16x32_bf16 v[20:23], v[220:223], v[164:167], v[20:23]
v_fmac_f32 v106, v94, v94
v_mfma_f32_16x16x32_bf16 v[24:27], v[220:223], v[168:171], v[24:27]
v_fmac_f32 v107, v95, v95
v_mfma_f32_16x16x32_bf16 v[28:31], v[220:223], v[172:175], v[28:31]
v_cmp_eq_u32 vcc, 15, v239
v_mfma_f32_16x16x32_bf16 v[32:35], v[220:223], v[176:179], v[32:35]
v_mov_b32 v124, 1132462080
v_mfma_f32_16x16x32_bf16 v[36:39], v[220:223], v[180:183], v[36:39]
v_mov_b32 v125, 1131675648
v_mfma_f32_16x16x32_bf16 v[40:43], v[220:223], v[184:187], v[40:43]
v_mov_b32 v241, 1131741184
v_mfma_f32_16x16x32_bf16 v[44:47], v[220:223], v[188:191], v[44:47]
v_mov_b32 v244, 1131413504
v_mfma_f32_16x16x32_bf16 v[48:51], v[220:223], v[192:195], v[48:51]
v_cndmask_b32 v124, v124, v241, vcc
v_mfma_f32_16x16x32_bf16 v[52:55], v[220:223], v[196:199], v[52:55]
v_cndmask_b32 v125, v125, v244, vcc
v_mfma_f32_16x16x32_bf16 v[56:59], v[220:223], v[200:203], v[56:59]
v_lshlrev_b32 v241, 5, v240
v_mfma_f32_16x16x32_bf16 v[60:63], v[220:223], v[204:207], v[60:63]
v_lshl_add_u32 v242, v239, 4, v241
s_waitcnt lgkmcnt(0)
v_mfma_f32_16x16x32_bf16 v[0:3], v[224:227], v[148:151], v[0:3]
ds_read_b64_tr_b16 v[248:249], v230 offset:57344
ds_read_b64_tr_b16 v[250:251], v230 offset:57600
v_mfma_f32_16x16x32_bf16 v[4:7], v[224:227], v[152:155], v[4:7]
ds_read_b128 v[144:147], v228 offset:512
v_mfma_f32_16x16x32_bf16 v[8:11], v[224:227], v[156:159], v[8:11]
v_lshl_add_u32 v243, v239, 7, v241
v_mfma_f32_16x16x32_bf16 v[12:15], v[224:227], v[160:163], v[12:15]
v_cmp_eq_u32 vcc, 0, v239
v_mfma_f32_16x16x32_bf16 v[16:19], v[224:227], v[164:167], v[16:19]
s_lshl_b32 s46, s41, 4
v_mfma_f32_16x16x32_bf16 v[20:23], v[224:227], v[168:171], v[20:23]
s_add_u32 s46, s46, s38
v_mfma_f32_16x16x32_bf16 v[24:27], v[224:227], v[172:175], v[24:27]
s_lshl_b32 s46, s46, 7
v_mfma_f32_16x16x32_bf16 v[28:31], v[224:227], v[176:179], v[28:31]
s_add_u32 s46, s46, s49
v_mfma_f32_16x16x32_bf16 v[32:35], v[224:227], v[180:183], v[32:35]
s_mov_b32 s86, 956518775
v_mfma_f32_16x16x32_bf16 v[36:39], v[224:227], v[184:187], v[36:39]
v_mov_b32 v244, 925353388
v_mfma_f32_16x16x32_bf16 v[40:43], v[224:227], v[188:191], v[40:43]
s_mov_b32 s48, 0
v_mfma_f32_16x16x32_bf16 v[44:47], v[224:227], v[192:195], v[44:47]
v_mfma_f32_16x16x32_bf16 v[48:51], v[224:227], v[196:199], v[48:51]
v_mfma_f32_16x16x32_bf16 v[52:55], v[224:227], v[200:203], v[52:55]
v_mfma_f32_16x16x32_bf16 v[56:59], v[224:227], v[204:207], v[56:59]
v_mfma_f32_16x16x32_bf16 v[60:63], v[224:227], v[208:211], v[60:63]
s_waitcnt lgkmcnt(0)
v_mfma_f32_16x16x32_bf16 v[0:3], v[248:251], v[152:155], v[0:3]
ds_read_b64_tr_b16 v[224:225], v230 offset:61440
ds_read_b64_tr_b16 v[226:227], v230 offset:61696
v_mfma_f32_16x16x32_bf16 v[4:7], v[248:251], v[156:159], v[4:7]
ds_read_b128 v[148:151], v228 offset:640
v_mfma_f32_16x16x32_bf16 v[8:11], v[248:251], v[160:163], v[8:11]
v_mfma_f32_16x16x32_bf16 v[12:15], v[248:251], v[164:167], v[12:15]
v_mfma_f32_16x16x32_bf16 v[16:19], v[248:251], v[168:171], v[16:19]
v_mfma_f32_16x16x32_bf16 v[20:23], v[248:251], v[172:175], v[20:23]
v_mfma_f32_16x16x32_bf16 v[24:27], v[248:251], v[176:179], v[24:27]
v_mfma_f32_16x16x32_bf16 v[28:31], v[248:251], v[180:183], v[28:31]
v_mfma_f32_16x16x32_bf16 v[32:35], v[248:251], v[184:187], v[32:35]
v_mfma_f32_16x16x32_bf16 v[36:39], v[248:251], v[188:191], v[36:39]
v_mfma_f32_16x16x32_bf16 v[40:43], v[248:251], v[192:195], v[40:43]
v_mfma_f32_16x16x32_bf16 v[44:47], v[248:251], v[196:199], v[44:47]
v_mfma_f32_16x16x32_bf16 v[48:51], v[248:251], v[200:203], v[48:51]
v_mfma_f32_16x16x32_bf16 v[52:55], v[248:251], v[204:207], v[52:55]
v_mfma_f32_16x16x32_bf16 v[56:59], v[248:251], v[208:211], v[56:59]
v_mfma_f32_16x16x32_bf16 v[60:63], v[248:251], v[212:215], v[60:63]
s_waitcnt lgkmcnt(0)
s_barrier
v_mfma_f32_16x16x32_bf16 v[0:3], v[224:227], v[156:159], v[0:3]
ds_read_b64_tr_b16 v[220:221], v230 offset:0
ds_read_b64_tr_b16 v[222:223], v230 offset:256
v_mfma_f32_16x16x32_bf16 v[4:7], v[224:227], v[160:163], v[4:7]
ds_read_b128 v[152:155], v228 offset:768
ds_read_b128 v[156:159], v228 offset:896
v_mfma_f32_16x16x32_bf16 v[8:11], v[224:227], v[164:167], v[8:11]
ds_read_b128 v[160:163], v228 offset:1024
ds_read_b128 v[164:167], v228 offset:1152
v_mfma_f32_16x16x32_bf16 v[12:15], v[224:227], v[168:171], v[12:15]
ds_read_b128 v[168:171], v228 offset:1280
v_mfma_f32_16x16x32_bf16 v[16:19], v[224:227], v[172:175], v[16:19]
ds_read_b128 v[172:175], v228 offset:1408
v_mfma_f32_16x16x32_bf16 v[20:23], v[224:227], v[176:179], v[20:23]
ds_read_b128 v[176:179], v228 offset:1536
v_mfma_f32_16x16x32_bf16 v[24:27], v[224:227], v[180:183], v[24:27]
ds_read_b128 v[180:183], v228 offset:1664
v_mfma_f32_16x16x32_bf16 v[28:31], v[224:227], v[184:187], v[28:31]
ds_read_b128 v[184:187], v228 offset:1792
v_mfma_f32_16x16x32_bf16 v[32:35], v[224:227], v[188:191], v[32:35]
ds_read_b128 v[188:191], v228 offset:1920
v_mfma_f32_16x16x32_bf16 v[36:39], v[224:227], v[192:195], v[36:39]
v_mfma_f32_16x16x32_bf16 v[40:43], v[224:227], v[196:199], v[40:43]
v_mfma_f32_16x16x32_bf16 v[44:47], v[224:227], v[200:203], v[44:47]
v_mfma_f32_16x16x32_bf16 v[48:51], v[224:227], v[204:207], v[48:51]
v_mfma_f32_16x16x32_bf16 v[52:55], v[224:227], v[208:211], v[52:55]
s_add_u32 s43, s43, 1
v_mfma_f32_16x16x32_bf16 v[56:59], v[224:227], v[212:215], v[56:59]
v_mfma_f32_16x16x32_bf16 v[60:63], v[224:227], v[216:219], v[60:63]
.p2align 4
L_loopQ:
s_waitcnt lgkmcnt(9)
v_mfma_f32_16x16x32_bf16 v[0:3], v[220:223], v[128:131], v[0:3]
ds_read_b64_tr_b16 v[224:225], v230 offset:4096
ds_read_b64_tr_b16 v[226:227], v230 offset:4352
v_mfma_f32_16x16x32_bf16 v[4:7], v[220:223], v[132:135], v[4:7]
ds_read_b128 v[192:195], v229 offset:0
ds_read_b128 v[196:199], v229 offset:128
v_mfma_f32_16x16x32_bf16 v[8:11], v[220:223], v[136:139], v[8:11]
ds_read_b128 v[200:203], v229 offset:256
v_mfma_f32_16x16x32_bf16 v[12:15], v[220:223], v[140:143], v[12:15]
v_mfma_f32_16x16x32_bf16 v[16:19], v[220:223], v[144:147], v[16:19]
v_mfma_f32_16x16x32_bf16 v[20:23], v[220:223], v[148:151], v[20:23]
v_mfma_f32_16x16x32_bf16 v[24:27], v[220:223], v[152:155], v[24:27]
s_waitcnt lgkmcnt(5)
v_mfma_f32_16x16x32_bf16 v[28:31], v[220:223], v[156:159], v[28:31]
v_mfma_f32_16x16x32_bf16 v[32:35], v[220:223], v[160:163], v[32:35]
v_mfma_f32_16x16x32_bf16 v[36:39], v[220:223], v[164:167], v[36:39]
v_mfma_f32_16x16x32_bf16 v[40:43], v[220:223], v[168:171], v[40:43]
v_mfma_f32_16x16x32_bf16 v[44:47], v[220:223], v[172:175], v[44:47]
v_mfma_f32_16x16x32_bf16 v[48:51], v[220:223], v[176:179], v[48:51]
v_mfma_f32_16x16x32_bf16 v[52:55], v[220:223], v[180:183], v[52:55]
v_mfma_f32_16x16x32_bf16 v[56:59], v[220:223], v[184:187], v[56:59]
v_mfma_f32_16x16x32_bf16 v[60:63], v[220:223], v[188:191], v[60:63]
s_waitcnt lgkmcnt(0)
v_mfma_f32_16x16x32_bf16 v[0:3], v[224:227], v[132:135], v[0:3]
ds_read_b64_tr_b16 v[220:221], v230 offset:8192
ds_read_b64_tr_b16 v[222:223], v230 offset:8448
v_mfma_f32_16x16x32_bf16 v[4:7], v[224:227], v[136:139], v[4:7]
ds_read_b128 v[204:207], v229 offset:384
ds_read_b128 v[208:211], v229 offset:512
v_mfma_f32_16x16x32_bf16 v[8:11], v[224:227], v[140:143], v[8:11]
v_mfma_f32_16x16x32_bf16 v[12:15], v[224:227], v[144:147], v[12:15]
v_mfma_f32_16x16x32_bf16 v[16:19], v[224:227], v[148:151], v[16:19]
v_mfma_f32_16x16x32_bf16 v[20:23], v[224:227], v[152:155], v[20:23]
v_mfma_f32_16x16x32_bf16 v[24:27], v[224:227], v[156:159], v[24:27]
v_mfma_f32_16x16x32_bf16 v[28:31], v[224:227], v[160:163], v[28:31]
v_mfma_f32_16x16x32_bf16 v[32:35], v[224:227], v[164:167], v[32:35]
v_mfma_f32_16x16x32_bf16 v[36:39], v[224:227], v[168:171], v[36:39]
v_mfma_f32_16x16x32_bf16 v[40:43], v[224:227], v[172:175], v[40:43]
v_mfma_f32_16x16x32_bf16 v[44:47], v[224:227], v[176:179], v[44:47]
v_mfma_f32_16x16x32_bf16 v[48:51], v[224:227], v[180:183], v[48:51]
v_mfma_f32_16x16x32_bf16 v[52:55], v[224:227], v[184:187], v[52:55]
v_mfma_f32_16x16x32_bf16 v[56:59], v[224:227], v[188:191], v[56:59]
v_mfma_f32_16x16x32_bf16 v[60:63], v[224:227], v[192:195], v[60:63]
s_waitcnt lgkmcnt(0)
v_mfma_f32_16x16x32_bf16 v[0:3], v[220:223], v[136:139], v[0:3]
ds_read_b64_tr_b16 v[224:225], v230 offset:12288
ds_read_b64_tr_b16 v[226:227], v230 offset:12544
v_mfma_f32_16x16x32_bf16 v[4:7], v[220:223], v[140:143], v[4:7]
ds_read_b128 v[212:215], v229 offset:640
ds_read_b128 v[216:219], v229 offset:768
v_mfma_f32_16x16x32_bf16 v[8:11], v[220:223], v[144:147], v[8:11]
v_mfma_f32_16x16x32_bf16 v[12:15], v[220:223], v[148:151], v[12:15]
v_mfma_f32_16x16x32_bf16 v[16:19], v[220:223], v[152:155], v[16:19]
v_mfma_f32_16x16x32_bf16 v[20:23], v[220:223], v[156:159], v[20:23]
v_mfma_f32_16x16x32_bf16 v[24:27], v[220:223], v[160:163], v[24:27]
v_mfma_f32_16x16x32_bf16 v[28:31], v[220:223], v[164:167], v[28:31]
v_mfma_f32_16x16x32_bf16 v[32:35], v[220:223], v[168:171], v[32:35]
v_mfma_f32_16x16x32_bf16 v[36:39], v[220:223], v[172:175], v[36:39]
v_mfma_f32_16x16x32_bf16 v[40:43], v[220:223], v[176:179], v[40:43]
v_mfma_f32_16x16x32_bf16 v[44:47], v[220:223], v[180:183], v[44:47]
v_mfma_f32_16x16x32_bf16 v[48:51], v[220:223], v[184:187], v[48:51]
v_mfma_f32_16x16x32_bf16 v[52:55], v[220:223], v[188:191], v[52:55]
v_mfma_f32_16x16x32_bf16 v[56:59], v[220:223], v[192:195], v[56:59]
v_mfma_f32_16x16x32_bf16 v[60:63], v[220:223], v[196:199], v[60:63]
s_waitcnt lgkmcnt(0)
s_barrier
v_mfma_f32_16x16x32_bf16 v[0:3], v[224:227], v[140:143], v[0:3]
ds_read_b64_tr_b16 v[220:221], v230 offset:16384
ds_read_b64_tr_b16 v[222:223], v230 offset:16640
v_mfma_f32_16x16x32_bf16 v[4:7], v[224:227], v[144:147], v[4:7]
ds_read_b128 v[128:131], v228 offset:34816
ds_read_b128 v[132:135], v228 offset:34944
v_mfma_f32_16x16x32_bf16 v[8:11], v[224:227], v[148:151], v[8:11]
ds_read_b128 v[136:139], v228 offset:35072
v_mfma_f32_16x16x32_bf16 v[12:15], v[224:227], v[152:155], v[12:15]
v_mfma_f32_16x16x32_bf16 v[16:19], v[224:227], v[156:159], v[16:19]
v_mfma_f32_16x16x32_bf16 v[20:23], v[224:227], v[160:163], v[20:23]
v_mfma_f32_16x16x32_bf16 v[24:27], v[224:227], v[164:167], v[24:27]
v_mfma_f32_16x16x32_bf16 v[28:31], v[224:227], v[168:171], v[28:31]
v_mfma_f32_16x16x32_bf16 v[32:35], v[224:227], v[172:175], v[32:35]
v_mfma_f32_16x16x32_bf16 v[36:39], v[224:227], v[176:179], v[36:39]
v_mfma_f32_16x16x32_bf16 v[40:43], v[224:227], v[180:183], v[40:43]
v_mfma_f32_16x16x32_bf16 v[44:47], v[224:227], v[184:187], v[44:47]
v_mfma_f32_16x16x32_bf16 v[48:51], v[224:227], v[188:191], v[48:51]
v_mfma_f32_16x16x32_bf16 v[52:55], v[224:227], v[192:195], v[52:55]
v_mfma_f32_16x16x32_bf16 v[56:59], v[224:227], v[196:199], v[56:59]
v_mfma_f32_16x16x32_bf16 v[60:63], v[224:227], v[200:203], v[60:63]
s_waitcnt lgkmcnt(0)
v_mfma_f32_16x16x32_bf16 v[0:3], v[220:223], v[144:147], v[0:3]
ds_read_b64_tr_b16 v[224:225], v230 offset:20480
ds_read_b64_tr_b16 v[226:227], v230 offset:20736
v_mfma_f32_16x16x32_bf16 v[4:7], v[220:223], v[148:151], v[4:7]
ds_read_b128 v[140:143], v228 offset:35200
v_mfma_f32_16x16x32_bf16 v[8:11], v[220:223], v[152:155], v[8:11]
v_mfma_f32_16x16x32_bf16 v[12:15], v[220:223], v[156:159], v[12:15]
v_mfma_f32_16x16x32_bf16 v[16:19], v[220:223], v[160:163], v[16:19]
v_mfma_f32_16x16x32_bf16 v[20:23], v[220:223], v[164:167], v[20:23]
v_mfma_f32_16x16x32_bf16 v[24:27], v[220:223], v[168:171], v[24:27]
v_mfma_f32_16x16x32_bf16 v[28:31], v[220:223], v[172:175], v[28:31]
v_mfma_f32_16x16x32_bf16 v[32:35], v[220:223], v[176:179], v[32:35]
v_mfma_f32_16x16x32_bf16 v[36:39], v[220:223], v[180:183], v[36:39]
v_mfma_f32_16x16x32_bf16 v[40:43], v[220:223], v[184:187], v[40:43]
v_mfma_f32_16x16x32_bf16 v[44:47], v[220:223], v[188:191], v[44:47]
v_mfma_f32_16x16x32_bf16 v[48:51], v[220:223], v[192:195], v[48:51]
v_mfma_f32_16x16x32_bf16 v[52:55], v[220:223], v[196:199], v[52:55]
v_mfma_f32_16x16x32_bf16 v[56:59], v[220:223], v[200:203], v[56:59]
v_mfma_f32_16x16x32_bf16 v[60:63], v[220:223], v[204:207], v[60:63]
s_waitcnt lgkmcnt(0)
v_mfma_f32_16x16x32_bf16 v[0:3], v[224:227], v[148:151], v[0:3]
ds_read_b64_tr_b16 v[220:221], v230 offset:24576
ds_read_b64_tr_b16 v[222:223], v230 offset:24832
v_mfma_f32_16x16x32_bf16 v[4:7], v[224:227], v[152:155], v[4:7]
ds_read_b128 v[144:147], v228 offset:35328
v_mfma_f32_16x16x32_bf16 v[8:11], v[224:227], v[156:159], v[8:11]
v_mfma_f32_16x16x32_bf16 v[12:15], v[224:227], v[160:163], v[12:15]
v_mfma_f32_16x16x32_bf16 v[16:19], v[224:227], v[164:167], v[16:19]
v_mfma_f32_16x16x32_bf16 v[20:23], v[224:227], v[168:171], v[20:23]
v_mfma_f32_16x16x32_bf16 v[24:27], v[224:227], v[172:175], v[24:27]
v_mfma_f32_16x16x32_bf16 v[28:31], v[224:227], v[176:179], v[28:31]
v_mfma_f32_16x16x32_bf16 v[32:35], v[224:227], v[180:183], v[32:35]
v_mfma_f32_16x16x32_bf16 v[36:39], v[224:227], v[184:187], v[36:39]
v_mfma_f32_16x16x32_bf16 v[40:43], v[224:227], v[188:191], v[40:43]
v_mfma_f32_16x16x32_bf16 v[44:47], v[224:227], v[192:195], v[44:47]
v_mfma_f32_16x16x32_bf16 v[48:51], v[224:227], v[196:199], v[48:51]
v_mfma_f32_16x16x32_bf16 v[52:55], v[224:227], v[200:203], v[52:55]
v_mfma_f32_16x16x32_bf16 v[56:59], v[224:227], v[204:207], v[56:59]
v_mfma_f32_16x16x32_bf16 v[60:63], v[224:227], v[208:211], v[60:63]
s_waitcnt lgkmcnt(0)
v_mfma_f32_16x16x32_bf16 v[0:3], v[220:223], v[152:155], v[0:3]
ds_read_b64_tr_b16 v[224:225], v230 offset:28672
ds_read_b64_tr_b16 v[226:227], v230 offset:28928
v_mfma_f32_16x16x32_bf16 v[4:7], v[220:223], v[156:159], v[4:7]
ds_read_b128 v[148:151], v228 offset:35456
v_mfma_f32_16x16x32_bf16 v[8:11], v[220:223], v[160:163], v[8:11]
v_mfma_f32_16x16x32_bf16 v[12:15], v[220:223], v[164:167], v[12:15]
v_mfma_f32_16x16x32_bf16 v[16:19], v[220:223], v[168:171], v[16:19]
v_mfma_f32_16x16x32_bf16 v[20:23], v[220:223], v[172:175], v[20:23]
v_mfma_f32_16x16x32_bf16 v[24:27], v[220:223], v[176:179], v[24:27]
v_mfma_f32_16x16x32_bf16 v[28:31], v[220:223], v[180:183], v[28:31]
v_mfma_f32_16x16x32_bf16 v[32:35], v[220:223], v[184:187], v[32:35]
v_mfma_f32_16x16x32_bf16 v[36:39], v[220:223], v[188:191], v[36:39]
v_mfma_f32_16x16x32_bf16 v[40:43], v[220:223], v[192:195], v[40:43]
v_mfma_f32_16x16x32_bf16 v[44:47], v[220:223], v[196:199], v[44:47]
v_mfma_f32_16x16x32_bf16 v[48:51], v[220:223], v[200:203], v[48:51]
v_mfma_f32_16x16x32_bf16 v[52:55], v[220:223], v[204:207], v[52:55]
v_mfma_f32_16x16x32_bf16 v[56:59], v[220:223], v[208:211], v[56:59]
v_mfma_f32_16x16x32_bf16 v[60:63], v[220:223], v[212:215], v[60:63]
s_waitcnt lgkmcnt(0)
s_barrier
v_mfma_f32_16x16x32_bf16 v[0:3], v[224:227], v[156:159], v[0:3]
ds_read_b64_tr_b16 v[220:221], v230 offset:32768
ds_read_b64_tr_b16 v[222:223], v230 offset:33024
v_mfma_f32_16x16x32_bf16 v[4:7], v[224:227], v[160:163], v[4:7]
ds_read_b128 v[152:155], v228 offset:35584
ds_read_b128 v[156:159], v228 offset:35712
v_mfma_f32_16x16x32_bf16 v[8:11], v[224:227], v[164:167], v[8:11]
ds_read_b128 v[160:163], v228 offset:35840
ds_read_b128 v[164:167], v228 offset:35968
v_mfma_f32_16x16x32_bf16 v[12:15], v[224:227], v[168:171], v[12:15]
ds_read_b128 v[168:171], v228 offset:36096
v_mfma_f32_16x16x32_bf16 v[16:19], v[224:227], v[172:175], v[16:19]
ds_read_b128 v[172:175], v228 offset:36224
v_mfma_f32_16x16x32_bf16 v[20:23], v[224:227], v[176:179], v[20:23]
ds_read_b128 v[176:179], v228 offset:36352
v_mfma_f32_16x16x32_bf16 v[24:27], v[224:227], v[180:183], v[24:27]
ds_read_b128 v[180:183], v228 offset:36480
v_mfma_f32_16x16x32_bf16 v[28:31], v[224:227], v[184:187], v[28:31]
ds_read_b128 v[184:187], v228 offset:36608
v_mfma_f32_16x16x32_bf16 v[32:35], v[224:227], v[188:191], v[32:35]
ds_read_b128 v[188:191], v228 offset:36736
v_mfma_f32_16x16x32_bf16 v[36:39], v[224:227], v[192:195], v[36:39]
v_mfma_f32_16x16x32_bf16 v[40:43], v[224:227], v[196:199], v[40:43]
v_mfma_f32_16x16x32_bf16 v[44:47], v[224:227], v[200:203], v[44:47]
v_mfma_f32_16x16x32_bf16 v[48:51], v[224:227], v[204:207], v[48:51]
v_mfma_f32_16x16x32_bf16 v[52:55], v[224:227], v[208:211], v[52:55]
v_mfma_f32_16x16x32_bf16 v[56:59], v[224:227], v[212:215], v[56:59]
v_mfma_f32_16x16x32_bf16 v[60:63], v[224:227], v[216:219], v[60:63]
s_waitcnt lgkmcnt(9)
v_mfma_f32_16x16x32_bf16 v[0:3], v[220:223], v[128:131], v[0:3]
ds_read_b64_tr_b16 v[224:225], v230 offset:36864
ds_read_b64_tr_b16 v[226:227], v230 offset:37120
v_mfma_f32_16x16x32_bf16 v[4:7], v[220:223], v[132:135], v[4:7]
ds_read_b128 v[192:195], v229 offset:34816
ds_read_b128 v[196:199], v229 offset:34944
v_mfma_f32_16x16x32_bf16 v[8:11], v[220:223], v[136:139], v[8:11]
ds_read_b128 v[200:203], v229 offset:35072
v_mfma_f32_16x16x32_bf16 v[12:15], v[220:223], v[140:143], v[12:15]
v_mfma_f32_16x16x32_bf16 v[16:19], v[220:223], v[144:147], v[16:19]
v_mfma_f32_16x16x32_bf16 v[20:23], v[220:223], v[148:151], v[20:23]
v_mfma_f32_16x16x32_bf16 v[24:27], v[220:223], v[152:155], v[24:27]
s_waitcnt lgkmcnt(5)
v_mfma_f32_16x16x32_bf16 v[28:31], v[220:223], v[156:159], v[28:31]
v_mfma_f32_16x16x32_bf16 v[32:35], v[220:223], v[160:163], v[32:35]
v_mfma_f32_16x16x32_bf16 v[36:39], v[220:223], v[164:167], v[36:39]
v_mfma_f32_16x16x32_bf16 v[40:43], v[220:223], v[168:171], v[40:43]
v_mfma_f32_16x16x32_bf16 v[44:47], v[220:223], v[172:175], v[44:47]
v_mfma_f32_16x16x32_bf16 v[48:51], v[220:223], v[176:179], v[48:51]
v_mfma_f32_16x16x32_bf16 v[52:55], v[220:223], v[180:183], v[52:55]
v_mfma_f32_16x16x32_bf16 v[56:59], v[220:223], v[184:187], v[56:59]
v_mfma_f32_16x16x32_bf16 v[60:63], v[220:223], v[188:191], v[60:63]
s_waitcnt lgkmcnt(0)
v_mfma_f32_16x16x32_bf16 v[0:3], v[224:227], v[132:135], v[0:3]
ds_read_b64_tr_b16 v[220:221], v230 offset:40960
ds_read_b64_tr_b16 v[222:223], v230 offset:41216
v_mfma_f32_16x16x32_bf16 v[4:7], v[224:227], v[136:139], v[4:7]
ds_read_b128 v[204:207], v229 offset:35200
ds_read_b128 v[208:211], v229 offset:35328
v_mfma_f32_16x16x32_bf16 v[8:11], v[224:227], v[140:143], v[8:11]
v_mfma_f32_16x16x32_bf16 v[12:15], v[224:227], v[144:147], v[12:15]
s_cmp_eq_u32 s43, 11
s_cselect_b32 s87, s49, 0x7f000000
v_mfma_f32_16x16x32_bf16 v[16:19], v[224:227], v[148:151], v[16:19]
v_mfma_f32_16x16x32_bf16 v[20:23], v[224:227], v[152:155], v[20:23]
v_mfma_f32_16x16x32_bf16 v[24:27], v[224:227], v[156:159], v[24:27]
v_mfma_f32_16x16x32_bf16 v[28:31], v[224:227], v[160:163], v[28:31]
v_mfma_f32_16x16x32_bf16 v[32:35], v[224:227], v[164:167], v[32:35]
buffer_load_dwordx4 v[108:111], v243, s[16:19], s87 offen offset:0 sc1
v_mfma_f32_16x16x32_bf16 v[36:39], v[224:227], v[168:171], v[36:39]
v_mfma_f32_16x16x32_bf16 v[40:43], v[224:227], v[172:175], v[40:43]
v_mfma_f32_16x16x32_bf16 v[44:47], v[224:227], v[176:179], v[44:47]
v_mfma_f32_16x16x32_bf16 v[48:51], v[224:227], v[180:183], v[48:51]
v_mfma_f32_16x16x32_bf16 v[52:55], v[224:227], v[184:187], v[52:55]
v_mfma_f32_16x16x32_bf16 v[56:59], v[224:227], v[188:191], v[56:59]
v_mfma_f32_16x16x32_bf16 v[60:63], v[224:227], v[192:195], v[60:63]
s_waitcnt lgkmcnt(0)
v_mfma_f32_16x16x32_bf16 v[0:3], v[220:223], v[136:139], v[0:3]
ds_read_b64_tr_b16 v[224:225], v230 offset:45056
ds_read_b64_tr_b16 v[226:227], v230 offset:45312
v_mfma_f32_16x16x32_bf16 v[4:7], v[220:223], v[140:143], v[4:7]
ds_read_b128 v[212:215], v229 offset:35456
ds_read_b128 v[216:219], v229 offset:35584
v_mfma_f32_16x16x32_bf16 v[8:11], v[220:223], v[144:147], v[8:11]
v_mfma_f32_16x16x32_bf16 v[12:15], v[220:223], v[148:151], v[12:15]
v_mfma_f32_16x16x32_bf16 v[16:19], v[220:223], v[152:155], v[16:19]
v_mfma_f32_16x16x32_bf16 v[20:23], v[220:223], v[156:159], v[20:23]
v_mfma_f32_16x16x32_bf16 v[24:27], v[220:223], v[160:163], v[24:27]
v_mfma_f32_16x16x32_bf16 v[28:31], v[220:223], v[164:167], v[28:31]
v_mfma_f32_16x16x32_bf16 v[32:35], v[220:223], v[168:171], v[32:35]
buffer_load_dwordx4 v[116:119], v243, s[16:19], s87 offen offset:2048 sc1
v_mfma_f32_16x16x32_bf16 v[36:39], v[220:223], v[172:175], v[36:39]
v_mfma_f32_16x16x32_bf16 v[40:43], v[220:223], v[176:179], v[40:43]
v_mfma_f32_16x16x32_bf16 v[44:47], v[220:223], v[180:183], v[44:47]
v_mfma_f32_16x16x32_bf16 v[48:51], v[220:223], v[184:187], v[48:51]
v_mfma_f32_16x16x32_bf16 v[52:55], v[220:223], v[188:191], v[52:55]
v_mfma_f32_16x16x32_bf16 v[56:59], v[220:223], v[192:195], v[56:59]
v_mfma_f32_16x16x32_bf16 v[60:63], v[220:223], v[196:199], v[60:63]
s_waitcnt lgkmcnt(0)
s_barrier
v_mfma_f32_16x16x32_bf16 v[0:3], v[224:227], v[140:143], v[0:3]
ds_read_b64_tr_b16 v[220:221], v230 offset:49152
ds_read_b64_tr_b16 v[222:223], v230 offset:49408
v_mfma_f32_16x16x32_bf16 v[4:7], v[224:227], v[144:147], v[4:7]
ds_read_b128 v[128:131], v228 offset:0
ds_read_b128 v[132:135], v228 offset:128
v_mfma_f32_16x16x32_bf16 v[8:11], v[224:227], v[148:151], v[8:11]
ds_read_b128 v[136:139], v228 offset:256
v_mfma_f32_16x16x32_bf16 v[12:15], v[224:227], v[152:155], v[12:15]
v_mfma_f32_16x16x32_bf16 v[16:19], v[224:227], v[156:159], v[16:19]
v_mfma_f32_16x16x32_bf16 v[20:23], v[224:227], v[160:163], v[20:23]
v_mfma_f32_16x16x32_bf16 v[24:27], v[224:227], v[164:167], v[24:27]
v_mfma_f32_16x16x32_bf16 v[28:31], v[224:227], v[168:171], v[28:31]
v_mfma_f32_16x16x32_bf16 v[32:35], v[224:227], v[172:175], v[32:35]
buffer_load_dwordx4 v[112:115], v243, s[16:19], s87 offen offset:16 sc1
v_mfma_f32_16x16x32_bf16 v[36:39], v[224:227], v[176:179], v[36:39]
v_mfma_f32_16x16x32_bf16 v[40:43], v[224:227], v[180:183], v[40:43]
v_mfma_f32_16x16x32_bf16 v[44:47], v[224:227], v[184:187], v[44:47]
v_mfma_f32_16x16x32_bf16 v[48:51], v[224:227], v[188:191], v[48:51]
v_mfma_f32_16x16x32_bf16 v[52:55], v[224:227], v[192:195], v[52:55]
v_mfma_f32_16x16x32_bf16 v[56:59], v[224:227], v[196:199], v[56:59]
v_mfma_f32_16x16x32_bf16 v[60:63], v[224:227], v[200:203], v[60:63]
s_waitcnt lgkmcnt(0)
v_mfma_f32_16x16x32_bf16 v[0:3], v[220:223], v[144:147], v[0:3]
ds_read_b64_tr_b16 v[224:225], v230 offset:53248
ds_read_b64_tr_b16 v[226:227], v230 offset:53504
v_mfma_f32_16x16x32_bf16 v[4:7], v[220:223], v[148:151], v[4:7]
ds_read_b128 v[140:143], v228 offset:384
v_mfma_f32_16x16x32_bf16 v[8:11], v[220:223], v[152:155], v[8:11]
v_mfma_f32_16x16x32_bf16 v[12:15], v[220:223], v[156:159], v[12:15]
v_mfma_f32_16x16x32_bf16 v[16:19], v[220:223], v[160:163], v[16:19]
v_mfma_f32_16x16x32_bf16 v[20:23], v[220:223], v[164:167], v[20:23]
v_mfma_f32_16x16x32_bf16 v[24:27], v[220:223], v[168:171], v[24:27]
v_mfma_f32_16x16x32_bf16 v[28:31], v[220:223], v[172:175], v[28:31]
v_mfma_f32_16x16x32_bf16 v[32:35], v[220:223], v[176:179], v[32:35]
buffer_load_dwordx4 v[120:123], v243, s[16:19], s87 offen offset:2064 sc1
v_mfma_f32_16x16x32_bf16 v[36:39], v[220:223], v[180:183], v[36:39]
v_mfma_f32_16x16x32_bf16 v[40:43], v[220:223], v[184:187], v[40:43]
v_mfma_f32_16x16x32_bf16 v[44:47], v[220:223], v[188:191], v[44:47]
v_mfma_f32_16x16x32_bf16 v[48:51], v[220:223], v[192:195], v[48:51]
v_mfma_f32_16x16x32_bf16 v[52:55], v[220:223], v[196:199], v[52:55]
v_mfma_f32_16x16x32_bf16 v[56:59], v[220:223], v[200:203], v[56:59]
v_mfma_f32_16x16x32_bf16 v[60:63], v[220:223], v[204:207], v[60:63]
s_waitcnt lgkmcnt(0)
v_mfma_f32_16x16x32_bf16 v[0:3], v[224:227], v[148:151], v[0:3]
ds_read_b64_tr_b16 v[248:249], v230 offset:57344
ds_read_b64_tr_b16 v[250:251], v230 offset:57600
v_mfma_f32_16x16x32_bf16 v[4:7], v[224:227], v[152:155], v[4:7]
ds_read_b128 v[144:147], v228 offset:512
v_mfma_f32_16x16x32_bf16 v[8:11], v[224:227], v[156:159], v[8:11]
v_mfma_f32_16x16x32_bf16 v[12:15], v[224:227], v[160:163], v[12:15]
v_mfma_f32_16x16x32_bf16 v[16:19], v[224:227], v[164:167], v[16:19]
v_mfma_f32_16x16x32_bf16 v[20:23], v[224:227], v[168:171], v[20:23]
v_mfma_f32_16x16x32_bf16 v[24:27], v[224:227], v[172:175], v[24:27]
v_mfma_f32_16x16x32_bf16 v[28:31], v[224:227], v[176:179], v[28:31]
v_mfma_f32_16x16x32_bf16 v[32:35], v[224:227], v[180:183], v[32:35]
v_mfma_f32_16x16x32_bf16 v[36:39], v[224:227], v[184:187], v[36:39]
v_mfma_f32_16x16x32_bf16 v[40:43], v[224:227], v[188:191], v[40:43]
v_mfma_f32_16x16x32_bf16 v[44:47], v[224:227], v[192:195], v[44:47]
v_mfma_f32_16x16x32_bf16 v[48:51], v[224:227], v[196:199], v[48:51]
v_mfma_f32_16x16x32_bf16 v[52:55], v[224:227], v[200:203], v[52:55]
v_mfma_f32_16x16x32_bf16 v[56:59], v[224:227], v[204:207], v[56:59]
v_mfma_f32_16x16x32_bf16 v[60:63], v[224:227], v[208:211], v[60:63]
s_waitcnt lgkmcnt(0)
v_mfma_f32_16x16x32_bf16 v[0:3], v[248:251], v[152:155], v[0:3]
ds_read_b64_tr_b16 v[224:225], v230 offset:61440
ds_read_b64_tr_b16 v[226:227], v230 offset:61696
v_mfma_f32_16x16x32_bf16 v[4:7], v[248:251], v[156:159], v[4:7]
ds_read_b128 v[148:151], v228 offset:640
v_mfma_f32_16x16x32_bf16 v[8:11], v[248:251], v[160:163], v[8:11]
v_mfma_f32_16x16x32_bf16 v[12:15], v[248:251], v[164:167], v[12:15]
v_mfma_f32_16x16x32_bf16 v[16:19], v[248:251], v[168:171], v[16:19]
v_mfma_f32_16x16x32_bf16 v[20:23], v[248:251], v[172:175], v[20:23]
v_mfma_f32_16x16x32_bf16 v[24:27], v[248:251], v[176:179], v[24:27]
v_mfma_f32_16x16x32_bf16 v[28:31], v[248:251], v[180:183], v[28:31]
v_mfma_f32_16x16x32_bf16 v[32:35], v[248:251], v[184:187], v[32:35]
v_mfma_f32_16x16x32_bf16 v[36:39], v[248:251], v[188:191], v[36:39]
v_mfma_f32_16x16x32_bf16 v[40:43], v[248:251], v[192:195], v[40:43]
v_mfma_f32_16x16x32_bf16 v[44:47], v[248:251], v[196:199], v[44:47]
v_mfma_f32_16x16x32_bf16 v[48:51], v[248:251], v[200:203], v[48:51]
v_mfma_f32_16x16x32_bf16 v[52:55], v[248:251], v[204:207], v[52:55]
v_mfma_f32_16x16x32_bf16 v[56:59], v[248:251], v[208:211], v[56:59]
v_mfma_f32_16x16x32_bf16 v[60:63], v[248:251], v[212:215], v[60:63]
s_waitcnt lgkmcnt(0)
s_barrier
v_mfma_f32_16x16x32_bf16 v[0:3], v[224:227], v[156:159], v[0:3]
ds_read_b64_tr_b16 v[220:221], v230 offset:0
ds_read_b64_tr_b16 v[222:223], v230 offset:256
v_mfma_f32_16x16x32_bf16 v[4:7], v[224:227], v[160:163], v[4:7]
ds_read_b128 v[152:155], v228 offset:768
ds_read_b128 v[156:159], v228 offset:896
v_mfma_f32_16x16x32_bf16 v[8:11], v[224:227], v[164:167], v[8:11]
ds_read_b128 v[160:163], v228 offset:1024
ds_read_b128 v[164:167], v228 offset:1152
v_mfma_f32_16x16x32_bf16 v[12:15], v[224:227], v[168:171], v[12:15]
ds_read_b128 v[168:171], v228 offset:1280
v_mfma_f32_16x16x32_bf16 v[16:19], v[224:227], v[172:175], v[16:19]
ds_read_b128 v[172:175], v228 offset:1408
v_mfma_f32_16x16x32_bf16 v[20:23], v[224:227], v[176:179], v[20:23]
ds_read_b128 v[176:179], v228 offset:1536
v_mfma_f32_16x16x32_bf16 v[24:27], v[224:227], v[180:183], v[24:27]
ds_read_b128 v[180:183], v228 offset:1664
v_mfma_f32_16x16x32_bf16 v[28:31], v[224:227], v[184:187], v[28:31]
ds_read_b128 v[184:187], v228 offset:1792
v_mfma_f32_16x16x32_bf16 v[32:35], v[224:227], v[188:191], v[32:35]
ds_read_b128 v[188:191], v228 offset:1920
v_mfma_f32_16x16x32_bf16 v[36:39], v[224:227], v[192:195], v[36:39]
v_mfma_f32_16x16x32_bf16 v[40:43], v[224:227], v[196:199], v[40:43]
v_mfma_f32_16x16x32_bf16 v[44:47], v[224:227], v[200:203], v[44:47]
v_mfma_f32_16x16x32_bf16 v[48:51], v[224:227], v[204:207], v[48:51]
v_mfma_f32_16x16x32_bf16 v[52:55], v[224:227], v[208:211], v[52:55]
s_add_u32 s43, s43, 1
v_mfma_f32_16x16x32_bf16 v[56:59], v[224:227], v[212:215], v[56:59]
s_cmp_lt_u32 s43, 12
v_mfma_f32_16x16x32_bf16 v[60:63], v[224:227], v[216:219], v[60:63]
s_cbranch_scc1 L_loopQ
s_cmp_lg_u32 s41, 0
s_cbranch_scc1 L_x1
ds_write_b128 v253, v[32:35] offset:0
ds_write_b128 v253, v[36:39] offset:1024
ds_write_b128 v253, v[40:43] offset:2048
ds_write_b128 v253, v[44:47] offset:3072
ds_write_b128 v253, v[48:51] offset:4096
ds_write_b128 v253, v[52:55] offset:5120
ds_write_b128 v253, v[56:59] offset:6144
ds_write_b128 v253, v[60:63] offset:7168
v_pk_add_f32 v[0:1], v[0:1], v[96:97]
v_pk_add_f32 v[2:3], v[2:3], v[98:99]
v_pk_add_f32 v[4:5], v[4:5], v[96:97]
v_pk_add_f32 v[6:7], v[6:7], v[98:99]
v_pk_add_f32 v[8:9], v[8:9], v[96:97]
v_pk_add_f32 v[10:11], v[10:11], v[98:99]
v_pk_add_f32 v[12:13], v[12:13], v[96:97]
v_pk_add_f32 v[14:15], v[14:15], v[98:99]
v_pk_add_f32 v[16:17], v[16:17], v[96:97]
v_pk_add_f32 v[18:19], v[18:19], v[98:99]
v_pk_add_f32 v[20:21], v[20:21], v[96:97]
v_pk_add_f32 v[22:23], v[22:23], v[98:99]
v_pk_add_f32 v[24:25], v[24:25], v[96:97]
v_pk_add_f32 v[26:27], v[26:27], v[98:99]
v_pk_add_f32 v[28:29], v[28:29], v[96:97]
v_pk_add_f32 v[30:31], v[30:31], v[98:99]
s_waitcnt lgkmcnt(0)
s_barrier
ds_read_b128 v[128:131], v254 offset:0
ds_read_b128 v[132:135], v254 offset:1024
ds_read_b128 v[136:139], v254 offset:2048
ds_read_b128 v[140:143], v254 offset:3072
ds_read_b128 v[144:147], v254 offset:4096
ds_read_b128 v[148:151], v254 offset:5120
ds_read_b128 v[152:155], v254 offset:6144
ds_read_b128 v[156:159], v254 offset:7168
s_mov_b64 exec, s[56:57]
s_waitcnt lgkmcnt(7)
v_pk_add_f32 v[0:1], v[0:1], v[128:129]
v_pk_add_f32 v[2:3], v[2:3], v[130:131]
v_pk_add_f32 v[100:101], v[100:101], v[0:1] neg_lo:[0,1] neg_hi:[0,1]
v_pk_add_f32 v[102:103], v[102:103], v[2:3] neg_lo:[0,1] neg_hi:[0,1]
v_pk_fma_f32 v[104:105], v[0:1], v[0:1], v[104:105]
v_pk_fma_f32 v[106:107], v[2:3], v[2:3], v[106:107]
s_mov_b64 exec, s[58:59]
s_waitcnt lgkmcnt(6)
v_pk_add_f32 v[4:5], v[4:5], v[132:133]
v_pk_add_f32 v[6:7], v[6:7], v[134:135]
v_pk_add_f32 v[100:101], v[100:101], v[4:5] neg_lo:[0,1] neg_hi:[0,1]
v_pk_add_f32 v[102:103], v[102:103], v[6:7] neg_lo:[0,1] neg_hi:[0,1]
v_pk_fma_f32 v[104:105], v[4:5], v[4:5], v[104:105]
v_pk_fma_f32 v[106:107], v[6:7], v[6:7], v[106:107]
s_mov_b64 exec, s[72:73]
s_waitcnt lgkmcnt(5)
v_pk_add_f32 v[8:9], v[8:9], v[136:137]
v_pk_add_f32 v[10:11], v[10:11], v[138:139]
v_pk_add_f32 v[100:101], v[100:101], v[8:9] neg_lo:[0,1] neg_hi:[0,1]
v_pk_add_f32 v[102:103], v[102:103], v[10:11] neg_lo:[0,1] neg_hi:[0,1]
v_pk_fma_f32 v[104:105], v[8:9], v[8:9], v[104:105]
v_pk_fma_f32 v[106:107], v[10:11], v[10:11], v[106:107]
s_mov_b64 exec, s[62:63]
s_waitcnt lgkmcnt(4)
v_pk_add_f32 v[12:13], v[12:13], v[140:141]
v_pk_add_f32 v[14:15], v[14:15], v[142:143]
v_pk_add_f32 v[100:101], v[100:101], v[12:13] neg_lo:[0,1] neg_hi:[0,1]
v_pk_add_f32 v[102:103], v[102:103], v[14:15] neg_lo:[0,1] neg_hi:[0,1]
v_pk_fma_f32 v[104:105], v[12:13], v[12:13], v[104:105]
v_pk_fma_f32 v[106:107], v[14:15], v[14:15], v[106:107]
s_mov_b64 exec, s[64:65]
s_waitcnt lgkmcnt(3)
v_pk_add_f32 v[16:17], v[16:17], v[144:145]
v_pk_add_f32 v[18:19], v[18:19], v[146:147]
v_pk_add_f32 v[100:101], v[100:101], v[16:17] neg_lo:[0,1] neg_hi:[0,1]
v_pk_add_f32 v[102:103], v[102:103], v[18:19] neg_lo:[0,1] neg_hi:[0,1]
v_pk_fma_f32 v[104:105], v[16:17], v[16:17], v[104:105]
v_pk_fma_f32 v[106:107], v[18:19], v[18:19], v[106:107]
s_mov_b64 exec, s[66:67]
s_waitcnt lgkmcnt(2)
v_pk_add_f32 v[20:21], v[20:21], v[148:149]
v_pk_add_f32 v[22:23], v[22:23], v[150:151]
v_pk_add_f32 v[100:101], v[100:101], v[20:21] neg_lo:[0,1] neg_hi:[0,1]
v_pk_add_f32 v[102:103], v[102:103], v[22:23] neg_lo:[0,1] neg_hi:[0,1]
v_pk_fma_f32 v[104:105], v[20:21], v[20:21], v[104:105]
v_pk_fma_f32 v[106:107], v[22:23], v[22:23], v[106:107]
s_mov_b64 exec, s[68:69]
s_waitcnt lgkmcnt(1)
v_pk_add_f32 v[24:25], v[24:25], v[152:153]
v_pk_add_f32 v[26:27], v[26:27], v[154:155]
v_pk_add_f32 v[100:101], v[100:101], v[24:25] neg_lo:[0,1] neg_hi:[0,1]
v_pk_add_f32 v[102:103], v[102:103], v[26:27] neg_lo:[0,1] neg_hi:[0,1]
v_pk_fma_f32 v[104:105], v[24:25], v[24:25], v[104:105]
v_pk_fma_f32 v[106:107], v[26:27], v[26:27], v[106:107]
s_mov_b64 exec, s[70:71]
s_waitcnt lgkmcnt(0)
v_pk_add_f32 v[28:29], v[28:29], v[156:157]
v_pk_add_f32 v[30:31], v[30:31], v[158:159]
v_pk_add_f32 v[100:101], v[100:101], v[28:29] neg_lo:[0,1] neg_hi:[0,1]
v_pk_add_f32 v[102:103], v[102:103], v[30:31] neg_lo:[0,1] neg_hi:[0,1]
v_pk_fma_f32 v[104:105], v[28:29], v[28:29], v[104:105]
v_pk_fma_f32 v[106:107], v[30:31], v[30:31], v[106:107]
s_mov_b64 exec, -1
s_branch L_x2
L_x1:
ds_write_b128 v253, v[0:3] offset:0
ds_write_b128 v253, v[4:7] offset:1024
ds_write_b128 v253, v[8:11] offset:2048
ds_write_b128 v253, v[12:15] offset:3072
ds_write_b128 v253, v[16:19] offset:4096
ds_write_b128 v253, v[20:23] offset:5120
ds_write_b128 v253, v[24:27] offset:6144
ds_write_b128 v253, v[28:31] offset:7168
v_pk_add_f32 v[32:33], v[32:33], v[96:97]
v_pk_add_f32 v[34:35], v[34:35], v[98:99]
v_pk_add_f32 v[36:37], v[36:37], v[96:97]
v_pk_add_f32 v[38:39], v[38:39], v[98:99]
v_pk_add_f32 v[40:41], v[40:41], v[96:97]
v_pk_add_f32 v[42:43], v[42:43], v[98:99]
v_pk_add_f32 v[44:45], v[44:45], v[96:97]
v_pk_add_f32 v[46:47], v[46:47], v[98:99]
v_pk_add_f32 v[48:49], v[48:49], v[96:97]
v_pk_add_f32 v[50:51], v[50:51], v[98:99]
v_pk_add_f32 v[52:53], v[52:53], v[96:97]
v_pk_add_f32 v[54:55], v[54:55], v[98:99]
v_pk_add_f32 v[56:57], v[56:57], v[96:97]
v_pk_add_f32 v[58:59], v[58:59], v[98:99]
v_pk_add_f32 v[60:61], v[60:61], v[96:97]
v_pk_add_f32 v[62:63], v[62:63], v[98:99]
s_waitcnt lgkmcnt(0)
s_barrier
ds_read_b128 v[128:131], v254 offset:0
ds_read_b128 v[132:135], v254 offset:1024
ds_read_b128 v[136:139], v254 offset:2048
ds_read_b128 v[140:143], v254 offset:3072
ds_read_b128 v[144:147], v254 offset:4096
ds_read_b128 v[148:151], v254 offset:5120
ds_read_b128 v[152:155], v254 offset:6144
ds_read_b128 v[156:159], v254 offset:7168
s_mov_b64 exec, s[56:57]
s_waitcnt lgkmcnt(7)
v_pk_add_f32 v[0:1], v[32:33], v[128:129]
v_pk_add_f32 v[2:3], v[34:35], v[130:131]
v_pk_add_f32 v[100:101], v[100:101], v[0:1] neg_lo:[0,1] neg_hi:[0,1]
v_pk_add_f32 v[102:103], v[102:103], v[2:3] neg_lo:[0,1] neg_hi:[0,1]
v_pk_fma_f32 v[104:105], v[0:1], v[0:1], v[104:105]
v_pk_fma_f32 v[106:107], v[2:3], v[2:3], v[106:107]
s_mov_b64 exec, s[58:59]
s_waitcnt lgkmcnt(6)
v_pk_add_f32 v[4:5], v[36:37], v[132:133]
v_pk_add_f32 v[6:7], v[38:39], v[134:135]
v_pk_add_f32 v[100:101], v[100:101], v[4:5] neg_lo:[0,1] neg_hi:[0,1]
v_pk_add_f32 v[102:103], v[102:103], v[6:7] neg_lo:[0,1] neg_hi:[0,1]
v_pk_fma_f32 v[104:105], v[4:5], v[4:5], v[104:105]
v_pk_fma_f32 v[106:107], v[6:7], v[6:7], v[106:107]
s_mov_b64 exec, s[72:73]
s_waitcnt lgkmcnt(5)
v_pk_add_f32 v[8:9], v[40:41], v[136:137]
v_pk_add_f32 v[10:11], v[42:43], v[138:139]
v_pk_add_f32 v[100:101], v[100:101], v[8:9] neg_lo:[0,1] neg_hi:[0,1]
v_pk_add_f32 v[102:103], v[102:103], v[10:11] neg_lo:[0,1] neg_hi:[0,1]
v_pk_fma_f32 v[104:105], v[8:9], v[8:9], v[104:105]
v_pk_fma_f32 v[106:107], v[10:11], v[10:11], v[106:107]
s_mov_b64 exec, s[62:63]
s_waitcnt lgkmcnt(4)
v_pk_add_f32 v[12:13], v[44:45], v[140:141]
v_pk_add_f32 v[14:15], v[46:47], v[142:143]
v_pk_add_f32 v[100:101], v[100:101], v[12:13] neg_lo:[0,1] neg_hi:[0,1]
v_pk_add_f32 v[102:103], v[102:103], v[14:15] neg_lo:[0,1] neg_hi:[0,1]
v_pk_fma_f32 v[104:105], v[12:13], v[12:13], v[104:105]
v_pk_fma_f32 v[106:107], v[14:15], v[14:15], v[106:107]
s_mov_b64 exec, s[64:65]
s_waitcnt lgkmcnt(3)
v_pk_add_f32 v[16:17], v[48:49], v[144:145]
v_pk_add_f32 v[18:19], v[50:51], v[146:147]
v_pk_add_f32 v[100:101], v[100:101], v[16:17] neg_lo:[0,1] neg_hi:[0,1]
v_pk_add_f32 v[102:103], v[102:103], v[18:19] neg_lo:[0,1] neg_hi:[0,1]
v_pk_fma_f32 v[104:105], v[16:17], v[16:17], v[104:105]
v_pk_fma_f32 v[106:107], v[18:19], v[18:19], v[106:107]
s_mov_b64 exec, s[66:67]
s_waitcnt lgkmcnt(2)
v_pk_add_f32 v[20:21], v[52:53], v[148:149]
v_pk_add_f32 v[22:23], v[54:55], v[150:151]
v_pk_add_f32 v[100:101], v[100:101], v[20:21] neg_lo:[0,1] neg_hi:[0,1]
v_pk_add_f32 v[102:103], v[102:103], v[22:23] neg_lo:[0,1] neg_hi:[0,1]
v_pk_fma_f32 v[104:105], v[20:21], v[20:21], v[104:105]
v_pk_fma_f32 v[106:107], v[22:23], v[22:23], v[106:107]
s_mov_b64 exec, s[68:69]
s_waitcnt lgkmcnt(1)
v_pk_add_f32 v[24:25], v[56:57], v[152:153]
v_pk_add_f32 v[26:27], v[58:59], v[154:155]
v_pk_add_f32 v[100:101], v[100:101], v[24:25] neg_lo:[0,1] neg_hi:[0,1]
v_pk_add_f32 v[102:103], v[102:103], v[26:27] neg_lo:[0,1] neg_hi:[0,1]
v_pk_fma_f32 v[104:105], v[24:25], v[24:25], v[104:105]
v_pk_fma_f32 v[106:107], v[26:27], v[26:27], v[106:107]
s_mov_b64 exec, s[70:71]
s_waitcnt lgkmcnt(0)
v_pk_add_f32 v[28:29], v[60:61], v[156:157]
v_pk_add_f32 v[30:31], v[62:63], v[158:159]
v_pk_add_f32 v[100:101], v[100:101], v[28:29] neg_lo:[0,1] neg_hi:[0,1]
v_pk_add_f32 v[102:103], v[102:103], v[30:31] neg_lo:[0,1] neg_hi:[0,1]
v_pk_fma_f32 v[104:105], v[28:29], v[28:29], v[104:105]
v_pk_fma_f32 v[106:107], v[30:31], v[30:31], v[106:107]
s_mov_b64 exec, -1
L_x2:
s_nop 1
v_add_f32_dpp v100, v100, v100 row_ror:8 row_mask:0xf bank_mask:0xf
v_add_f32_dpp v101, v101, v101 row_ror:8 row_mask:0xf bank_mask:0xf
v_add_f32_dpp v102, v102, v102 row_ror:8 row_mask:0xf bank_mask:0xf
v_add_f32_dpp v103, v103, v103 row_ror:8 row_mask:0xf bank_mask:0xf
v_add_f32_dpp v104, v104, v104 row_ror:8 row_mask:0xf bank_mask:0xf
v_add_f32_dpp v105, v105, v105 row_ror:8 row_mask:0xf bank_mask:0xf
v_add_f32_dpp v106, v106, v106 row_ror:8 row_mask:0xf bank_mask:0xf
v_add_f32_dpp v107, v107, v107 row_ror:8 row_mask:0xf bank_mask:0xf
v_add_f32_dpp v100, v100, v100 row_ror:4 row_mask:0xf bank_mask:0xf
v_add_f32_dpp v101, v101, v101 row_ror:4 row_mask:0xf bank_mask:0xf
v_add_f32_dpp v102, v102, v102 row_ror:4 row_mask:0xf bank_mask:0xf
v_add_f32_dpp v103, v103, v103 row_ror:4 row_mask:0xf bank_mask:0xf
v_add_f32_dpp v104, v104, v104 row_ror:4 row_mask:0xf bank_mask:0xf
v_add_f32_dpp v105, v105, v105 row_ror:4 row_mask:0xf bank_mask:0xf
v_add_f32_dpp v106, v106, v106 row_ror:4 row_mask:0xf bank_mask:0xf
v_add_f32_dpp v107, v107, v107 row_ror:4 row_mask:0xf bank_mask:0xf
v_add_f32_dpp v100, v100, v100 row_ror:2 row_mask:0xf bank_mask:0xf
v_add_f32_dpp v101, v101, v101 row_ror:2 row_mask:0xf bank_mask:0xf
v_add_f32_dpp v102, v102, v102 row_ror:2 row_mask:0xf bank_mask:0xf
v_add_f32_dpp v103, v103, v103 row_ror:2 row_mask:0xf bank_mask:0xf
v_add_f32_dpp v104, v104, v104 row_ror:2 row_mask:0xf bank_mask:0xf
v_add_f32_dpp v105, v105, v105 row_ror:2 row_mask:0xf bank_mask:0xf
v_add_f32_dpp v106, v106, v106 row_ror:2 row_mask:0xf bank_mask:0xf
v_add_f32_dpp v107, v107, v107 row_ror:2 row_mask:0xf bank_mask:0xf
v_add_f32_dpp v100, v100, v100 row_ror:1 row_mask:0xf bank_mask:0xf
v_add_f32_dpp v101, v101, v101 row_ror:1 row_mask:0xf bank_mask:0xf
v_add_f32_dpp v102, v102, v102 row_ror:1 row_mask:0xf bank_mask:0xf
v_add_f32_dpp v103, v103, v103 row_ror:1 row_mask:0xf bank_mask:0xf
v_add_f32_dpp v104, v104, v104 row_ror:1 row_mask:0xf bank_mask:0xf
v_add_f32_dpp v105, v105, v105 row_ror:1 row_mask:0xf bank_mask:0xf
v_add_f32_dpp v106, v106, v106 row_ror:1 row_mask:0xf bank_mask:0xf
v_add_f32_dpp v107, v107, v107 row_ror:1 row_mask:0xf bank_mask:0xf
v_mul_f32 v128, s54, v100
v_mul_f32 v129, s54, v101
v_mul_f32 v130, s54, v102
v_mul_f32 v131, s54, v103
v_fma_f32 v104, -v100, v128, v104
v_fma_f32 v105, -v101, v129, v105
v_fma_f32 v106, -v102, v130, v106
v_fma_f32 v107, -v103, v131, v107
v_add_f32 v128, v128, v96
v_add_f32 v129, v129, v97
v_add_f32 v130, v130, v98
v_add_f32 v131, v131, v99
v_cndmask_b32 v132, v104, v128, vcc
v_cndmask_b32 v133, v105, v129, vcc
v_cndmask_b32 v134, v106, v130, vcc
v_cndmask_b32 v135, v107, v131, vcc
s_mov_b32 exec_lo, 0x00030003
s_mov_b32 exec_hi, 0x00030003
buffer_store_dwordx4 v[132:135], v242, s[16:19], s46 offen sc1
s_mov_b64 exec, -1
s_waitcnt vmcnt(1)
v_max3_u32 v136, v108, v109, v110
v_max3_u32 v137, v111, v112, v113
v_max3_u32 v138, v116, v117, v118
v_max3_u32 v139, v119, v120, v121
v_max3_u32 v136, v136, v114, v115
v_max3_u32 v138, v138, v122, v123
v_max_u32 v136, v136, v137
v_max_u32 v138, v138, v139
v_cmp_eq_u32 s[76:77], -1, v136
v_cmp_eq_u32 s[78:79], -1, v138
s_add_u32 s48, s48, 1
s_or_b64 vcc, s[76:77], s[78:79]
s_cbranch_scc0 L_poll0
s_mov_b64 exec, s[76:77]
s_cbranch_execz L_pr00
buffer_load_dwordx4 v[108:111], v243, s[16:19], s49 offen offset:0 sc1
buffer_load_dwordx4 v[112:115], v243, s[16:19], s49 offen offset:16 sc1
L_pr00:
s_mov_b64 exec, s[78:79]
s_cbranch_execz L_pr01
buffer_load_dwordx4 v[116:119], v243, s[16:19], s49 offen offset:2048 sc1
buffer_load_dwordx4 v[120:123], v243, s[16:19], s49 offen offset:2064 sc1
L_pr01:
s_mov_b64 exec, -1
L_poll0:
v_lshlrev_b32 v160, 16, v232
v_and_b32 v161, 0xffff0000, v232
v_lshlrev_b32 v162, 16, v233
v_and_b32 v163, 0xffff0000, v233
v_lshlrev_b32 v164, 16, v234
v_and_b32 v165, 0xffff0000, v234
v_lshlrev_b32 v166, 16, v235
v_and_b32 v167, 0xffff0000, v235
v_lshlrev_b32 v168, 16, v236
v_and_b32 v169, 0xffff0000, v236
v_lshlrev_b32 v170, 16, v237
v_and_b32 v171, 0xffff0000, v237
v_mov_b32 v172, 3222493025
v_mov_b32 v174, 3184710632
v_mov_b32 v173, 3222493025
v_mov_b32 v175, 3184710632
v_add_f32 v96, v96, v160
v_add_f32 v97, v97, v161
v_add_f32 v98, v98, v162
v_add_f32 v99, v99, v163
s_cbranch_vccz L_pollx
L_poll:
s_waitcnt vmcnt(0)
v_max3_u32 v136, v108, v109, v110
v_max3_u32 v137, v111, v112, v113
v_max3_u32 v138, v116, v117, v118
v_max3_u32 v139, v119, v120, v121
v_max3_u32 v136, v136, v114, v115
v_max3_u32 v138, v138, v122, v123
v_max_u32 v136, v136, v137
v_max_u32 v138, v138, v139
v_cmp_eq_u32 s[76:77], -1, v136
v_cmp_eq_u32 s[78:79], -1, v138
s_add_u32 s48, s48, 1
s_or_b64 vcc, s[76:77], s[78:79]
s_cbranch_scc0 L_pollx
s_mov_b64 exec, s[76:77]
s_cbranch_execz L_pr10
buffer_load_dwordx4 v[108:111], v243, s[16:19], s49 offen offset:0 sc1
buffer_load_dwordx4 v[112:115], v243, s[16:19], s49 offen offset:16 sc1
L_pr10:
s_mov_b64 exec, s[78:79]
s_cbranch_execz L_pr11
buffer_load_dwordx4 v[116:119], v243, s[16:19], s49 offen offset:2048 sc1
buffer_load_dwordx4 v[120:123], v243, s[16:19], s49 offen offset:2064 sc1
L_pr11:
s_mov_b64 exec, -1
s_cmp_lt_u32 s48, 0x20000
s_cbranch_scc1 L_poll
s_waitcnt vmcnt(0)
L_pollx:
v_mov_b32_dpp v152, v108 row_newbcast:0 row_mask:0xf bank_mask:0xf
v_mov_b32_dpp v153, v109 row_newbcast:0 row_mask:0xf bank_mask:0xf
v_mov_b32_dpp v154, v110 row_newbcast:0 row_mask:0xf bank_mask:0xf
v_mov_b32_dpp v155, v111 row_newbcast:0 row_mask:0xf bank_mask:0xf
v_sub_f32 v144, v108, v152
v_sub_f32 v145, v109, v153
v_sub_f32 v146, v110, v154
v_sub_f32 v147, v111, v155
v_sub_f32 v148, v116, v152
v_sub_f32 v149, v117, v153
v_sub_f32 v150, v118, v154
v_sub_f32 v151, v119, v155
v_mul_f32 v108, v144, v124
v_mul_f32 v109, v145, v124
v_mul_f32 v110, v146, v124
v_mul_f32 v111, v147, v124
v_mul_f32 v116, v148, v125
v_mul_f32 v117, v149, v125
v_mul_f32 v118, v150, v125
v_mul_f32 v119, v151, v125
v_add_f32 v140, v112, v120
v_add_f32 v141, v113, v121
v_add_f32 v142, v114, v122
v_add_f32 v143, v115, v123
v_add_f32 v136, v108, v116
v_add_f32 v137, v109, v117
v_add_f32 v138, v110, v118
v_add_f32 v139, v111, v119
v_fmac_f32 v140, v144, v108
v_fmac_f32 v141, v145, v109
v_fmac_f32 v142, v146, v110
v_fmac_f32 v143, v147, v111
v_fmac_f32 v140, v148, v116
v_fmac_f32 v141, v149, v117
v_fmac_f32 v142, v150, v118
v_fmac_f32 v143, v151, v119
v_add_f32 v152, v152, v160
v_add_f32 v153, v153, v161
v_add_f32 v154, v154, v162
v_add_f32 v155, v155, v163
v_add_f32_dpp v136, v136, v136 row_ror:8 row_mask:0xf bank_mask:0xf
v_add_f32_dpp v137, v137, v137 row_ror:8 row_mask:0xf bank_mask:0xf
v_add_f32_dpp v138, v138, v138 row_ror:8 row_mask:0xf bank_mask:0xf
v_add_f32_dpp v139, v139, v139 row_ror:8 row_mask:0xf bank_mask:0xf
v_add_f32_dpp v140, v140, v140 row_ror:8 row_mask:0xf bank_mask:0xf
v_add_f32_dpp v141, v141, v141 row_ror:8 row_mask:0xf bank_mask:0xf
v_add_f32_dpp v142, v142, v142 row_ror:8 row_mask:0xf bank_mask:0xf
v_add_f32_dpp v143, v143, v143 row_ror:8 row_mask:0xf bank_mask:0xf
v_add_f32_dpp v136, v136, v136 row_ror:4 row_mask:0xf bank_mask:0xf
v_add_f32_dpp v137, v137, v137 row_ror:4 row_mask:0xf bank_mask:0xf
v_add_f32_dpp v138, v138, v138 row_ror:4 row_mask:0xf bank_mask:0xf
v_add_f32_dpp v139, v139, v139 row_ror:4 row_mask:0xf bank_mask:0xf
v_add_f32_dpp v140, v140, v140 row_ror:4 row_mask:0xf bank_mask:0xf
v_add_f32_dpp v141, v141, v141 row_ror:4 row_mask:0xf bank_mask:0xf
v_add_f32_dpp v142, v142, v142 row_ror:4 row_mask:0xf bank_mask:0xf
v_add_f32_dpp v143, v143, v143 row_ror:4 row_mask:0xf bank_mask:0xf
v_add_f32_dpp v136, v136, v136 row_ror:2 row_mask:0xf bank_mask:0xf
v_add_f32_dpp v137, v137, v137 row_ror:2 row_mask:0xf bank_mask:0xf
v_add_f32_dpp v138, v138, v138 row_ror:2 row_mask:0xf bank_mask:0xf
v_add_f32_dpp v139, v139, v139 row_ror:2 row_mask:0xf bank_mask:0xf
v_add_f32_dpp v140, v140, v140 row_ror:2 row_mask:0xf bank_mask:0xf
v_add_f32_dpp v141, v141, v141 row_ror:2 row_mask:0xf bank_mask:0xf
v_add_f32_dpp v142, v142, v142 row_ror:2 row_mask:0xf bank_mask:0xf
v_add_f32_dpp v143, v143, v143 row_ror:2 row_mask:0xf bank_mask:0xf
v_add_f32_dpp v136, v136, v136 row_ror:1 row_mask:0xf bank_mask:0xf
v_add_f32_dpp v137, v137, v137 row_ror:1 row_mask:0xf bank_mask:0xf
v_add_f32_dpp v138, v138, v138 row_ror:1 row_mask:0xf bank_mask:0xf
v_add_f32_dpp v139, v139, v139 row_ror:1 row_mask:0xf bank_mask:0xf
v_add_f32_dpp v140, v140, v140 row_ror:1 row_mask:0xf bank_mask:0xf
v_add_f32_dpp v141, v141, v141 row_ror:1 row_mask:0xf bank_mask:0xf
v_add_f32_dpp v142, v142, v142 row_ror:1 row_mask:0xf bank_mask:0xf
v_add_f32_dpp v143, v143, v143 row_ror:1 row_mask:0xf bank_mask:0xf
v_mul_f32 v136, s86, v136
v_mul_f32 v137, s86, v137
v_mul_f32 v138, s86, v138
v_mul_f32 v139, s86, v139
v_fma_f32 v140, v140, s86, v244
v_fma_f32 v141, v141, s86, v244
v_fma_f32 v142, v142, s86, v244
v_fma_f32 v143, v143, s86, v244
v_fma_f32 v140, -v136, v136, v140
v_fma_f32 v141, -v137, v137, v141
v_fma_f32 v142, -v138, v138, v142
v_fma_f32 v143, -v139, v139, v143
v_add_f32 v136, v136, v152
v_add_f32 v137, v137, v153
v_add_f32 v138, v138, v154
v_add_f32 v139, v139, v155
v_rsq_f32 v140, v140
v_rsq_f32 v141, v141
v_rsq_f32 v142, v142
v_rsq_f32 v143, v143
v_sub_f32 v136, v96, v136
v_sub_f32 v137, v97, v137
v_sub_f32 v138, v98, v138
v_sub_f32 v139, v99, v139
v_mul_f32 v152, v140, v164
v_mul_f32 v153, v141, v165
v_mul_f32 v154, v142, v166
v_mul_f32 v155, v143, v167
v_fma_f32 v156, v136, v152, v168
v_fma_f32 v157, v137, v153, v169
v_fma_f32 v158, v138, v154, v170
v_fma_f32 v159, v139, v155, v171
v_pk_fma_f32 v[64:65], v[64:65], v[152:153], v[156:157]
v_pk_fma_f32 v[66:67], v[66:67], v[154:155], v[158:159]
v_pk_fma_f32 v[0:1], v[0:1], v[152:153], v[156:157] neg_lo:[1,0,0] neg_hi:[1,0,0]
v_pk_fma_f32 v[2:3], v[2:3], v[154:155], v[158:159] neg_lo:[1,0,0] neg_hi:[1,0,0]
v_pk_mul_f32 v[176:177], v[64:65], v[64:65]
v_pk_mul_f32 v[178:179], v[66:67], v[66:67]
v_pk_mul_f32 v[180:181], v[0:1], v[0:1]
v_pk_mul_f32 v[182:183], v[2:3], v[2:3]
v_pk_fma_f32 v[176:177], v[176:177], v[174:175], v[172:173]
v_pk_fma_f32 v[178:179], v[178:179], v[174:175], v[172:173]
v_pk_fma_f32 v[180:181], v[180:181], v[174:175], v[172:173]
v_pk_fma_f32 v[182:183], v[182:183], v[174:175], v[172:173]
v_pk_mul_f32 v[176:177], v[176:177], v[64:65]
v_pk_mul_f32 v[178:179], v[178:179], v[66:67]
v_pk_mul_f32 v[180:181], v[180:181], v[0:1]
v_pk_mul_f32 v[182:183], v[182:183], v[2:3]
v_exp_f32 v176, v176
v_exp_f32 v177, v177
v_exp_f32 v178, v178
v_exp_f32 v179, v179
v_exp_f32 v180, v180
v_exp_f32 v181, v181
v_exp_f32 v182, v182
v_exp_f32 v183, v183
v_pk_add_f32 v[176:177], v[176:177], 1.0 op_sel_hi:[1,0]
v_pk_add_f32 v[178:179], v[178:179], 1.0 op_sel_hi:[1,0]
v_pk_add_f32 v[180:181], v[180:181], 1.0 op_sel_hi:[1,0]
v_pk_add_f32 v[182:183], v[182:183], 1.0 op_sel_hi:[1,0]
v_rcp_f32 v176, v176
v_rcp_f32 v177, v177
v_rcp_f32 v178, v178
v_rcp_f32 v179, v179
v_rcp_f32 v180, v180
v_rcp_f32 v181, v181
v_rcp_f32 v182, v182
v_rcp_f32 v183, v183
v_pk_mul_f32 v[176:177], v[176:177], v[64:65]
v_pk_mul_f32 v[178:179], v[178:179], v[66:67]
v_pk_mul_f32 v[180:181], v[180:181], v[0:1]
v_pk_mul_f32 v[182:183], v[182:183], v[2:3]
v_cvt_pk_bf16_f32 v192, v176, v177
v_cvt_pk_bf16_f32 v193, v178, v179
v_cvt_pk_bf16_f32 v194, v180, v181
v_cvt_pk_bf16_f32 v195, v182, v183
v_pk_fma_f32 v[68:69], v[68:69], v[152:153], v[156:157]
v_pk_fma_f32 v[70:71], v[70:71], v[154:155], v[158:159]
v_pk_fma_f32 v[4:5], v[4:5], v[152:153], v[156:157] neg_lo:[1,0,0] neg_hi:[1,0,0]
v_pk_fma_f32 v[6:7], v[6:7], v[154:155], v[158:159] neg_lo:[1,0,0] neg_hi:[1,0,0]
v_permlane16_swap_b32 v192, v194
v_permlane16_swap_b32 v193, v195
s_mov_b64 exec, s[56:57]
buffer_store_dwordx4 v[192:195], v245, s[12:15], 0 offen offset:0
s_mov_b64 exec, -1
v_pk_mul_f32 v[184:185], v[68:69], v[68:69]
v_pk_mul_f32 v[186:187], v[70:71], v[70:71]
v_pk_mul_f32 v[188:189], v[4:5], v[4:5]
v_pk_mul_f32 v[190:191], v[6:7], v[6:7]
v_pk_fma_f32 v[184:185], v[184:185], v[174:175], v[172:173]
v_pk_fma_f32 v[186:187], v[186:187], v[174:175], v[172:173]
v_pk_fma_f32 v[188:189], v[188:189], v[174:175], v[172:173]
v_pk_fma_f32 v[190:191], v[190:191], v[174:175], v[172:173]
v_pk_mul_f32 v[184:185], v[184:185], v[68:69]
v_pk_mul_f32 v[186:187], v[186:187], v[70:71]
v_pk_mul_f32 v[188:189], v[188:189], v[4:5]
v_pk_mul_f32 v[190:191], v[190:191], v[6:7]
v_exp_f32 v184, v184
v_exp_f32 v185, v185
v_exp_f32 v186, v186
v_exp_f32 v187, v187
v_exp_f32 v188, v188
v_exp_f32 v189, v189
v_exp_f32 v190, v190
v_exp_f32 v191, v191
v_pk_add_f32 v[184:185], v[184:185], 1.0 op_sel_hi:[1,0]
v_pk_add_f32 v[186:187], v[186:187], 1.0 op_sel_hi:[1,0]
v_pk_add_f32 v[188:189], v[188:189], 1.0 op_sel_hi:[1,0]
v_pk_add_f32 v[190:191], v[190:191], 1.0 op_sel_hi:[1,0]
v_rcp_f32 v184, v184
v_rcp_f32 v185, v185
v_rcp_f32 v186, v186
v_rcp_f32 v187, v187
v_rcp_f32 v188, v188
v_rcp_f32 v189, v189
v_rcp_f32 v190, v190
v_rcp_f32 v191, v191
v_pk_mul_f32 v[184:185], v[184:185], v[68:69]
v_pk_mul_f32 v[186:187], v[186:187], v[70:71]
v_pk_mul_f32 v[188:189], v[188:189], v[4:5]
v_pk_mul_f32 v[190:191], v[190:191], v[6:7]
v_cvt_pk_bf16_f32 v196, v184, v185
v_cvt_pk_bf16_f32 v197, v186, v187
v_cvt_pk_bf16_f32 v198, v188, v189
v_cvt_pk_bf16_f32 v199, v190, v191
v_pk_fma_f32 v[72:73], v[72:73], v[152:153], v[156:157]
v_pk_fma_f32 v[74:75], v[74:75], v[154:155], v[158:159]
v_pk_fma_f32 v[8:9], v[8:9], v[152:153], v[156:157] neg_lo:[1,0,0] neg_hi:[1,0,0]
v_pk_fma_f32 v[10:11], v[10:11], v[154:155], v[158:159] neg_lo:[1,0,0] neg_hi:[1,0,0]
v_permlane16_swap_b32 v196, v198
v_permlane16_swap_b32 v197, v199
s_mov_b64 exec, s[58:59]
buffer_store_dwordx4 v[196:199], v245, s[12:15], 0 offen offset:1024
s_mov_b64 exec, -1
v_pk_mul_f32 v[176:177], v[72:73], v[72:73]
v_pk_mul_f32 v[178:179], v[74:75], v[74:75]
v_pk_mul_f32 v[180:181], v[8:9], v[8:9]
v_pk_mul_f32 v[182:183], v[10:11], v[10:11]
v_pk_fma_f32 v[176:177], v[176:177], v[174:175], v[172:173]
v_pk_fma_f32 v[178:179], v[178:179], v[174:175], v[172:173]
v_pk_fma_f32 v[180:181], v[180:181], v[174:175], v[172:173]
v_pk_fma_f32 v[182:183], v[182:183], v[174:175], v[172:173]
v_pk_mul_f32 v[176:177], v[176:177], v[72:73]
v_pk_mul_f32 v[178:179], v[178:179], v[74:75]
v_pk_mul_f32 v[180:181], v[180:181], v[8:9]
v_pk_mul_f32 v[182:183], v[182:183], v[10:11]
v_exp_f32 v176, v176
v_exp_f32 v177, v177
v_exp_f32 v178, v178
v_exp_f32 v179, v179
v_exp_f32 v180, v180
v_exp_f32 v181, v181
v_exp_f32 v182, v182
v_exp_f32 v183, v183
v_pk_add_f32 v[176:177], v[176:177], 1.0 op_sel_hi:[1,0]
v_pk_add_f32 v[178:179], v[178:179], 1.0 op_sel_hi:[1,0]
v_pk_add_f32 v[180:181], v[180:181], 1.0 op_sel_hi:[1,0]
v_pk_add_f32 v[182:183], v[182:183], 1.0 op_sel_hi:[1,0]
v_rcp_f32 v176, v176
v_rcp_f32 v177, v177
v_rcp_f32 v178, v178
v_rcp_f32 v179, v179
v_rcp_f32 v180, v180
v_rcp_f32 v181, v181
v_rcp_f32 v182, v182
v_rcp_f32 v183, v183
v_pk_mul_f32 v[176:177], v[176:177], v[72:73]
v_pk_mul_f32 v[178:179], v[178:179], v[74:75]
v_pk_mul_f32 v[180:181], v[180:181], v[8:9]
v_pk_mul_f32 v[182:183], v[182:183], v[10:11]
v_cvt_pk_bf16_f32 v200, v176, v177
v_cvt_pk_bf16_f32 v201, v178, v179
v_cvt_pk_bf16_f32 v202, v180, v181
v_cvt_pk_bf16_f32 v203, v182, v183
v_pk_fma_f32 v[76:77], v[76:77], v[152:153], v[156:157]
v_pk_fma_f32 v[78:79], v[78:79], v[154:155], v[158:159]
v_pk_fma_f32 v[12:13], v[12:13], v[152:153], v[156:157] neg_lo:[1,0,0] neg_hi:[1,0,0]
v_pk_fma_f32 v[14:15], v[14:15], v[154:155], v[158:159] neg_lo:[1,0,0] neg_hi:[1,0,0]
v_permlane16_swap_b32 v200, v202
v_permlane16_swap_b32 v201, v203
s_mov_b64 exec, s[74:75]
buffer_store_dwordx4 v[200:203], v245, s[12:15], 0 offen offset:2048
s_mov_b64 exec, -1
v_pk_mul_f32 v[184:185], v[76:77], v[76:77]
v_pk_mul_f32 v[186:187], v[78:79], v[78:79]
v_pk_mul_f32 v[188:189], v[12:13], v[12:13]
v_pk_mul_f32 v[190:191], v[14:15], v[14:15]
v_pk_fma_f32 v[184:185], v[184:185], v[174:175], v[172:173]
v_pk_fma_f32 v[186:187], v[186:187], v[174:175], v[172:173]
v_pk_fma_f32 v[188:189], v[188:189], v[174:175], v[172:173]
v_pk_fma_f32 v[190:191], v[190:191], v[174:175], v[172:173]
v_pk_mul_f32 v[184:185], v[184:185], v[76:77]
v_pk_mul_f32 v[186:187], v[186:187], v[78:79]
v_pk_mul_f32 v[188:189], v[188:189], v[12:13]
v_pk_mul_f32 v[190:191], v[190:191], v[14:15]
v_exp_f32 v184, v184
v_exp_f32 v185, v185
v_exp_f32 v186, v186
v_exp_f32 v187, v187
v_exp_f32 v188, v188
v_exp_f32 v189, v189
v_exp_f32 v190, v190
v_exp_f32 v191, v191
v_pk_add_f32 v[184:185], v[184:185], 1.0 op_sel_hi:[1,0]
v_pk_add_f32 v[186:187], v[186:187], 1.0 op_sel_hi:[1,0]
v_pk_add_f32 v[188:189], v[188:189], 1.0 op_sel_hi:[1,0]
v_pk_add_f32 v[190:191], v[190:191], 1.0 op_sel_hi:[1,0]
v_rcp_f32 v184, v184
v_rcp_f32 v185, v185
v_rcp_f32 v186, v186
v_rcp_f32 v187, v187
v_rcp_f32 v188, v188
v_rcp_f32 v189, v189
v_rcp_f32 v190, v190
v_rcp_f32 v191, v191
v_pk_mul_f32 v[184:185], v[184:185], v[76:77]
v_pk_mul_f32 v[186:187], v[186:187], v[78:79]
v_pk_mul_f32 v[188:189], v[188:189], v[12:13]
v_pk_mul_f32 v[190:191], v[190:191], v[14:15]
v_cvt_pk_bf16_f32 v204, v184, v185
v_cvt_pk_bf16_f32 v205, v186, v187
v_cvt_pk_bf16_f32 v206, v188, v189
v_cvt_pk_bf16_f32 v207, v190, v191
v_pk_fma_f32 v[80:81], v[80:81], v[152:153], v[156:157]
v_pk_fma_f32 v[82:83], v[82:83], v[154:155], v[158:159]
v_pk_fma_f32 v[16:17], v[16:17], v[152:153], v[156:157] neg_lo:[1,0,0] neg_hi:[1,0,0]
v_pk_fma_f32 v[18:19], v[18:19], v[154:155], v[158:159] neg_lo:[1,0,0] neg_hi:[1,0,0]
v_permlane16_swap_b32 v204, v206
v_permlane16_swap_b32 v205, v207
s_mov_b64 exec, s[62:63]
buffer_store_dwordx4 v[204:207], v245, s[12:15], 0 offen offset:3072
s_mov_b64 exec, -1
v_pk_mul_f32 v[176:177], v[80:81], v[80:81]
v_pk_mul_f32 v[178:179], v[82:83], v[82:83]
v_pk_mul_f32 v[180:181], v[16:17], v[16:17]
v_pk_mul_f32 v[182:183], v[18:19], v[18:19]
v_pk_fma_f32 v[176:177], v[176:177], v[174:175], v[172:173]
v_pk_fma_f32 v[178:179], v[178:179], v[174:175], v[172:173]
v_pk_fma_f32 v[180:181], v[180:181], v[174:175], v[172:173]
v_pk_fma_f32 v[182:183], v[182:183], v[174:175], v[172:173]
v_pk_mul_f32 v[176:177], v[176:177], v[80:81]
v_pk_mul_f32 v[178:179], v[178:179], v[82:83]
v_pk_mul_f32 v[180:181], v[180:181], v[16:17]
v_pk_mul_f32 v[182:183], v[182:183], v[18:19]
v_exp_f32 v176, v176
v_exp_f32 v177, v177
v_exp_f32 v178, v178
v_exp_f32 v179, v179
v_exp_f32 v180, v180
v_exp_f32 v181, v181
v_exp_f32 v182, v182
v_exp_f32 v183, v183
v_pk_add_f32 v[176:177], v[176:177], 1.0 op_sel_hi:[1,0]
v_pk_add_f32 v[178:179], v[178:179], 1.0 op_sel_hi:[1,0]
v_pk_add_f32 v[180:181], v[180:181], 1.0 op_sel_hi:[1,0]
v_pk_add_f32 v[182:183], v[182:183], 1.0 op_sel_hi:[1,0]
v_rcp_f32 v176, v176
v_rcp_f32 v177, v177
v_rcp_f32 v178, v178
v_rcp_f32 v179, v179
v_rcp_f32 v180, v180
v_rcp_f32 v181, v181
v_rcp_f32 v182, v182
v_rcp_f32 v183, v183
v_pk_mul_f32 v[176:177], v[176:177], v[80:81]
v_pk_mul_f32 v[178:179], v[178:179], v[82:83]
v_pk_mul_f32 v[180:181], v[180:181], v[16:17]
v_pk_mul_f32 v[182:183], v[182:183], v[18:19]
v_cvt_pk_bf16_f32 v192, v176, v177
v_cvt_pk_bf16_f32 v193, v178, v179
v_cvt_pk_bf16_f32 v194, v180, v181
v_cvt_pk_bf16_f32 v195, v182, v183
v_pk_fma_f32 v[84:85], v[84:85], v[152:153], v[156:157]
v_pk_fma_f32 v[86:87], v[86:87], v[154:155], v[158:159]
v_pk_fma_f32 v[20:21], v[20:21], v[152:153], v[156:157] neg_lo:[1,0,0] neg_hi:[1,0,0]
v_pk_fma_f32 v[22:23], v[22:23], v[154:155], v[158:159] neg_lo:[1,0,0] neg_hi:[1,0,0]
v_permlane16_swap_b32 v192, v194
v_permlane16_swap_b32 v193, v195
s_mov_b64 exec, s[64:65]
buffer_store_dwordx4 v[192:195], v245, s[12:15], s85 offen offset:0
s_mov_b64 exec, -1
v_pk_mul_f32 v[184:185], v[84:85], v[84:85]
v_pk_mul_f32 v[186:187], v[86:87], v[86:87]
v_pk_mul_f32 v[188:189], v[20:21], v[20:21]
v_pk_mul_f32 v[190:191], v[22:23], v[22:23]
v_pk_fma_f32 v[184:185], v[184:185], v[174:175], v[172:173]
v_pk_fma_f32 v[186:187], v[186:187], v[174:175], v[172:173]
v_pk_fma_f32 v[188:189], v[188:189], v[174:175], v[172:173]
v_pk_fma_f32 v[190:191], v[190:191], v[174:175], v[172:173]
v_pk_mul_f32 v[184:185], v[184:185], v[84:85]
v_pk_mul_f32 v[186:187], v[186:187], v[86:87]
v_pk_mul_f32 v[188:189], v[188:189], v[20:21]
v_pk_mul_f32 v[190:191], v[190:191], v[22:23]
v_exp_f32 v184, v184
v_exp_f32 v185, v185
v_exp_f32 v186, v186
v_exp_f32 v187, v187
v_exp_f32 v188, v188
v_exp_f32 v189, v189
v_exp_f32 v190, v190
v_exp_f32 v191, v191
v_pk_add_f32 v[184:185], v[184:185], 1.0 op_sel_hi:[1,0]
v_pk_add_f32 v[186:187], v[186:187], 1.0 op_sel_hi:[1,0]
v_pk_add_f32 v[188:189], v[188:189], 1.0 op_sel_hi:[1,0]
v_pk_add_f32 v[190:191], v[190:191], 1.0 op_sel_hi:[1,0]
v_rcp_f32 v184, v184
v_rcp_f32 v185, v185
v_rcp_f32 v186, v186
v_rcp_f32 v187, v187
v_rcp_f32 v188, v188
v_rcp_f32 v189, v189
v_rcp_f32 v190, v190
v_rcp_f32 v191, v191
v_pk_mul_f32 v[184:185], v[184:185], v[84:85]
v_pk_mul_f32 v[186:187], v[186:187], v[86:87]
v_pk_mul_f32 v[188:189], v[188:189], v[20:21]
v_pk_mul_f32 v[190:191], v[190:191], v[22:23]
v_cvt_pk_bf16_f32 v196, v184, v185
v_cvt_pk_bf16_f32 v197, v186, v187
v_cvt_pk_bf16_f32 v198, v188, v189
v_cvt_pk_bf16_f32 v199, v190, v191
v_pk_fma_f32 v[88:89], v[88:89], v[152:153], v[156:157]
v_pk_fma_f32 v[90:91], v[90:91], v[154:155], v[158:159]
v_pk_fma_f32 v[24:25], v[24:25], v[152:153], v[156:157] neg_lo:[1,0,0] neg_hi:[1,0,0]
v_pk_fma_f32 v[26:27], v[26:27], v[154:155], v[158:159] neg_lo:[1,0,0] neg_hi:[1,0,0]
v_permlane16_swap_b32 v196, v198
v_permlane16_swap_b32 v197, v199
s_mov_b64 exec, s[66:67]
buffer_store_dwordx4 v[196:199], v245, s[12:15], s85 offen offset:1024
s_mov_b64 exec, -1
v_pk_mul_f32 v[176:177], v[88:89], v[88:89]
v_pk_mul_f32 v[178:179], v[90:91], v[90:91]
v_pk_mul_f32 v[180:181], v[24:25], v[24:25]
v_pk_mul_f32 v[182:183], v[26:27], v[26:27]
v_pk_fma_f32 v[176:177], v[176:177], v[174:175], v[172:173]
v_pk_fma_f32 v[178:179], v[178:179], v[174:175], v[172:173]
v_pk_fma_f32 v[180:181], v[180:181], v[174:175], v[172:173]
v_pk_fma_f32 v[182:183], v[182:183], v[174:175], v[172:173]
v_pk_mul_f32 v[176:177], v[176:177], v[88:89]
v_pk_mul_f32 v[178:179], v[178:179], v[90:91]
v_pk_mul_f32 v[180:181], v[180:181], v[24:25]
v_pk_mul_f32 v[182:183], v[182:183], v[26:27]
v_exp_f32 v176, v176
v_exp_f32 v177, v177
v_exp_f32 v178, v178
v_exp_f32 v179, v179
v_exp_f32 v180, v180
v_exp_f32 v181, v181
v_exp_f32 v182, v182
v_exp_f32 v183, v183
v_pk_add_f32 v[176:177], v[176:177], 1.0 op_sel_hi:[1,0]
v_pk_add_f32 v[178:179], v[178:179], 1.0 op_sel_hi:[1,0]
v_pk_add_f32 v[180:181], v[180:181], 1.0 op_sel_hi:[1,0]
v_pk_add_f32 v[182:183], v[182:183], 1.0 op_sel_hi:[1,0]
v_rcp_f32 v176, v176
v_rcp_f32 v177, v177
v_rcp_f32 v178, v178
v_rcp_f32 v179, v179
v_rcp_f32 v180, v180
v_rcp_f32 v181, v181
v_rcp_f32 v182, v182
v_rcp_f32 v183, v183
v_pk_mul_f32 v[176:177], v[176:177], v[88:89]
v_pk_mul_f32 v[178:179], v[178:179], v[90:91]
v_pk_mul_f32 v[180:181], v[180:181], v[24:25]
v_pk_mul_f32 v[182:183], v[182:183], v[26:27]
v_cvt_pk_bf16_f32 v200, v176, v177
v_cvt_pk_bf16_f32 v201, v178, v179
v_cvt_pk_bf16_f32 v202, v180, v181
v_cvt_pk_bf16_f32 v203, v182, v183
v_pk_fma_f32 v[92:93], v[92:93], v[152:153], v[156:157]
v_pk_fma_f32 v[94:95], v[94:95], v[154:155], v[158:159]
v_pk_fma_f32 v[28:29], v[28:29], v[152:153], v[156:157] neg_lo:[1,0,0] neg_hi:[1,0,0]
v_pk_fma_f32 v[30:31], v[30:31], v[154:155], v[158:159] neg_lo:[1,0,0] neg_hi:[1,0,0]
v_permlane16_swap_b32 v200, v202
v_permlane16_swap_b32 v201, v203
s_mov_b64 exec, s[68:69]
buffer_store_dwordx4 v[200:203], v245, s[12:15], s85 offen offset:2048
s_mov_b64 exec, -1
v_pk_mul_f32 v[184:185], v[92:93], v[92:93]
v_pk_mul_f32 v[186:187], v[94:95], v[94:95]
v_pk_mul_f32 v[188:189], v[28:29], v[28:29]
v_pk_mul_f32 v[190:191], v[30:31], v[30:31]
v_pk_fma_f32 v[184:185], v[184:185], v[174:175], v[172:173]
v_pk_fma_f32 v[186:187], v[186:187], v[174:175], v[172:173]
v_pk_fma_f32 v[188:189], v[188:189], v[174:175], v[172:173]
v_pk_fma_f32 v[190:191], v[190:191], v[174:175], v[172:173]
v_pk_mul_f32 v[184:185], v[184:185], v[92:93]
v_pk_mul_f32 v[186:187], v[186:187], v[94:95]
v_pk_mul_f32 v[188:189], v[188:189], v[28:29]
v_pk_mul_f32 v[190:191], v[190:191], v[30:31]
v_exp_f32 v184, v184
v_exp_f32 v185, v185
v_exp_f32 v186, v186
v_exp_f32 v187, v187
v_exp_f32 v188, v188
v_exp_f32 v189, v189
v_exp_f32 v190, v190
v_exp_f32 v191, v191
v_pk_add_f32 v[184:185], v[184:185], 1.0 op_sel_hi:[1,0]
v_pk_add_f32 v[186:187], v[186:187], 1.0 op_sel_hi:[1,0]
v_pk_add_f32 v[188:189], v[188:189], 1.0 op_sel_hi:[1,0]
v_pk_add_f32 v[190:191], v[190:191], 1.0 op_sel_hi:[1,0]
v_rcp_f32 v184, v184
v_rcp_f32 v185, v185
v_rcp_f32 v186, v186
v_rcp_f32 v187, v187
v_rcp_f32 v188, v188
v_rcp_f32 v189, v189
v_rcp_f32 v190, v190
v_rcp_f32 v191, v191
v_pk_mul_f32 v[184:185], v[184:185], v[92:93]
v_pk_mul_f32 v[186:187], v[186:187], v[94:95]
v_pk_mul_f32 v[188:189], v[188:189], v[28:29]
v_pk_mul_f32 v[190:191], v[190:191], v[30:31]
v_cvt_pk_bf16_f32 v204, v184, v185
v_cvt_pk_bf16_f32 v205, v186, v187
v_cvt_pk_bf16_f32 v206, v188, v189
v_cvt_pk_bf16_f32 v207, v190, v191
s_nop 1
v_permlane16_swap_b32 v204, v206
v_permlane16_swap_b32 v205, v207
s_mov_b64 exec, s[70:71]
buffer_store_dwordx4 v[204:207], v245, s[12:15], s85 offen offset:3072
s_mov_b64 exec, -1
L_end:
s_endpgm
.section .rodata,"a"
.p2align 6
.amdhsa_kernel standalone__self_sup_conv_stem_hubert__speech_kernel
  .amdhsa_next_free_vgpr 256
  .amdhsa_next_free_sgpr 102
  .amdhsa_accum_offset 256
  .amdhsa_group_segment_fixed_size 0
  .amdhsa_kernarg_size 64
  .amdhsa_user_sgpr_count 2
  .amdhsa_user_sgpr_kernarg_segment_ptr 1
  .amdhsa_system_sgpr_workgroup_id_x 1
.end_amdhsa_kernel
```
